```python
import torch

def _softmax(x, axis=-1):
    return torch.softmax(x, dim=axis)
def _gelu(x):
    return torch.nn.functional.gelu(x, approximate="tanh")
def _silu(x):
    return torch.nn.functional.silu(x)
def _sigmoid(x):
    return torch.sigmoid(x)
def _layernorm(x, axis=-1, eps=1e-5):
    m = x.mean(dim=axis, keepdim=True)
    v = x.var(dim=axis, keepdim=True, unbiased=False)
    return (x - m) / torch.sqrt(v + eps)
def _scatter_add(tgt, idx, src, axis=0):
    return tgt.clone().index_add_(axis, idx, src)
def _segment_sum(src, seg, n):
    out = torch.zeros((n,) + src.shape[1:], dtype=src.dtype)
    return out.index_add_(0, seg, src)
def _pad(x, pw):
    flat = tuple(v for pair in reversed(pw) for v in pair)
    return torch.nn.functional.pad(x, flat)

kernel_name = 'standalone__edge_featured_mpnn_gatedgcn__graph'

def setup_inputs():

    _w = (lambda a: (lambda t: t.to(torch.bfloat16) if t.is_floating_point() else t)(torch.as_tensor(a)))
    N, deg, D, De = 25000, 32, 64, max(0, 1)
    E = N * deg
    return {
        "x": _w((lambda *s: torch.randn(*s, dtype=torch.bfloat16) * 0.8)(N, D)),
        "e_attr": _w((lambda *s: torch.randn(*s, dtype=torch.bfloat16) * 0.8)(E, De)),
        "src": _w((lambda lo, hi, *s: torch.randint(lo, hi, s))(0, N, E).to(torch.int64)),
        "dst": _w((lambda lo, hi, *s: torch.randint(lo, hi, s))(0, N, E).to(torch.int64)),
        "w_a": _w((lambda *s: torch.randn(*s, dtype=torch.bfloat16) * 0.8)(D, D)),
        "w_b": _w((lambda *s: torch.randn(*s, dtype=torch.bfloat16) * 0.8)(D, D)),
        "w_c": _w((lambda *s: torch.randn(*s, dtype=torch.bfloat16) * 0.8)(De, D)),
        "w_u": _w((lambda *s: torch.randn(*s, dtype=torch.bfloat16) * 0.05)(D, D)),
        "w_v": _w((lambda *s: torch.randn(*s, dtype=torch.bfloat16) * 0.05)(D, D)),
    }

def reference(x, e_attr, src, dst, w_a, w_b, w_c, w_u, w_v):
    N, D = x.shape
    hv = x @ w_v
    g = x[dst] @ w_a + x[src] @ w_b + e_attr @ w_c
    eta = _sigmoid(g)
    denom = _segment_sum(eta, dst, N) + 1e-6
    eta_n = eta / denom[dst]
    agg = _segment_sum(eta_n * hv[src], dst, N)
    z = x @ w_u + agg
    relu_z = torch.where(z > 0, z, 0 * z)
    return x + relu_z
```

```asm
; @launch kernel=k1_kernel grid=(456,1,1) block=(512,1,1) lds=65664
; @launch kernel=k2_kernel grid=(256,1,1) block=(1024,1,1) lds=159232
.amdgcn_target "amdgcn-amd-amdhsa--gfx950"
.text
.globl k1_kernel
.p2align 8
.type k1_kernel,@function
k1_kernel:
    s_cmp_ge_u32 s2, 8
    s_cbranch_scc1 k1_npf
    v_cmp_le_u32 vcc, 448, v0
    s_cbranch_vccz k1_npf
    s_getpc_b64 s[32:33]
k1_pc:
    v_and_b32 v60, 63, v0
    v_lshlrev_b32 v60, 7, v60
    v_add_u32 v61, 0x2000, v60
    v_min_u32 v61, k2_slow-k1_pc, v61
    global_load_dword v60, v60, s[32:33]
    global_load_dword v61, v61, s[32:33]
k1_npf:
    s_cmp_ge_u32 s2, 456
    s_cbranch_scc1 k1_end
    s_add_u32 s2, s2, 200
    s_cmp_ge_u32 s2, 456
    s_cselect_b32 s3, 456, 0
    s_sub_u32 s2, s2, s3
    s_cmp_lt_u32 s2, 200
    s_cbranch_scc1 k1_gemm
    s_sub_u32 s3, s2, 200
    s_cmp_ge_u32 s3, 250
    s_cbranch_scc1 k1_wf
    s_setprio 3
    s_load_dwordx2 s[8:9], s[0:1], 24
    s_load_dwordx4 s[4:7], s[0:1], 8
    s_load_dwordx2 s[10:11], s[0:1], 88
    v_lshlrev_b32 v3, 2, v0
    v_mov_b32 v4, 0
    ds_write_b32 v3, v4 offset:16384
    v_lshlrev_b32 v1, 5, v0
    s_mul_i32 s12, s3, 12800
    v_add_u32 v1, s12, v1
    v_lshrrev_b32 v2, 1, v1
    v_mov_b32 v5, 1
    v_and_b32 v6, 63, v0
    v_lshlrev_b32 v6, 3, v6
    s_mov_b32 s16, 0xffff0000
    s_movk_i32 s17, 0x1fc
    v_cmp_gt_u32 vcc, 400, v0
    s_mov_b64 s[14:15], vcc
    s_mov_b64 exec, vcc
    s_waitcnt lgkmcnt(0)
    s_cbranch_execz k1_b1
    global_load_dwordx4 v[8:11], v1, s[8:9] nt
    global_load_dwordx4 v[12:15], v1, s[8:9] offset:16 nt
k1_b1:
    s_barrier
    s_cbranch_execnz k1_b1w
    s_mov_b64 exec, -1
    s_add_u32 s20, s6, s12
    s_addc_u32 s21, s7, 0
    s_movk_i32 s22, 12800
    s_mov_b32 s23, 0x20000
    s_lshr_b32 s13, s12, 1
    s_add_u32 s24, s4, s13
    s_addc_u32 s25, s5, 0
    s_movk_i32 s26, 6400
    s_mov_b32 s27, 0x20000
    v_lshlrev_b32 v1, 1, v6
    s_movk_i32 m0, 20480
    s_nop 0
    buffer_load_dwordx4 v1, s[20:23], 0 offen offset:0 nt lds
    s_waitcnt vmcnt(0)
    buffer_load_dwordx4 v1, s[20:23], 0 offen offset:1024 nt lds
    buffer_load_dwordx4 v1, s[20:23], 0 offen offset:2048 nt lds
    buffer_load_dwordx4 v1, s[20:23], 0 offen offset:3072 nt lds
    s_movk_i32 m0, 24576
    v_add_u32 v1, 0x1000, v1
    buffer_load_dwordx4 v1, s[20:23], 0 offen offset:0 nt lds
    buffer_load_dwordx4 v1, s[20:23], 0 offen offset:1024 nt lds
    buffer_load_dwordx4 v1, s[20:23], 0 offen offset:2048 nt lds
    buffer_load_dwordx4 v1, s[20:23], 0 offen offset:3072 nt lds
    s_movk_i32 m0, 28672
    v_add_u32 v1, 0x1000, v1
    buffer_load_dwordx4 v1, s[20:23], 0 offen offset:0 nt lds
    buffer_load_dwordx4 v1, s[20:23], 0 offen offset:1024 nt lds
    buffer_load_dwordx4 v1, s[20:23], 0 offen offset:2048 nt lds
    buffer_load_dwordx4 v1, s[20:23], 0 offen offset:3072 nt lds
    s_mov_b32 m0, 32768
    v_add_u32 v1, 0x1000, v1
    buffer_load_dwordx4 v1, s[20:23], 0 offen offset:0 nt lds
    v_lshlrev_b32 v1, 1, v6
    s_mov_b32 m0, 33792
    s_nop 0
    buffer_load_dwordx4 v1, s[24:27], 0 offen offset:0 nt lds
    buffer_load_dwordx4 v1, s[24:27], 0 offen offset:1024 nt lds
    buffer_load_dwordx4 v1, s[24:27], 0 offen offset:2048 nt lds
    buffer_load_dwordx4 v1, s[24:27], 0 offen offset:3072 nt lds
    s_mov_b32 m0, 37888
    v_add_u32 v1, 0x1000, v1
    buffer_load_dwordx4 v1, s[24:27], 0 offen offset:0 nt lds
    buffer_load_dwordx4 v1, s[24:27], 0 offen offset:1024 nt lds
    buffer_load_dwordx4 v1, s[24:27], 0 offen offset:2048 nt lds
    s_branch k1_b2
k1_b1w:
    s_waitcnt vmcnt(0)
    v_lshlrev_b32 v28, 2, v8
    v_and_b32 v28, s17, v28
    ds_add_rtn_u32 v36, v28, v5 offset:16384
    v_lshlrev_b32 v29, 2, v9
    v_and_b32 v29, s17, v29
    ds_add_rtn_u32 v37, v29, v5 offset:16384
    v_lshlrev_b32 v30, 2, v10
    v_and_b32 v30, s17, v30
    ds_add_rtn_u32 v38, v30, v5 offset:16384
    v_lshlrev_b32 v31, 2, v11
    v_and_b32 v31, s17, v31
    ds_add_rtn_u32 v39, v31, v5 offset:16384
    v_lshlrev_b32 v32, 2, v12
    v_and_b32 v32, s17, v32
    ds_add_rtn_u32 v40, v32, v5 offset:16384
    v_lshlrev_b32 v33, 2, v13
    v_and_b32 v33, s17, v33
    ds_add_rtn_u32 v41, v33, v5 offset:16384
    v_lshlrev_b32 v34, 2, v14
    v_and_b32 v34, s17, v34
    ds_add_rtn_u32 v42, v34, v5 offset:16384
    v_lshlrev_b32 v35, 2, v15
    v_and_b32 v35, s17, v35
    ds_add_rtn_u32 v43, v35, v5 offset:16384
k1_b2:
    s_mov_b64 exec, -1
    s_waitcnt lgkmcnt(0)
    s_barrier
    ds_read_b64 v[44:45], v6 offset:16384
    v_lshrrev_b32 v8, 7, v8
    v_lshrrev_b32 v9, 7, v9
    v_lshrrev_b32 v10, 7, v10
    v_lshrrev_b32 v11, 7, v11
    v_lshrrev_b32 v12, 7, v12
    v_lshrrev_b32 v13, 7, v13
    v_lshrrev_b32 v14, 7, v14
    v_lshrrev_b32 v15, 7, v15
    s_waitcnt lgkmcnt(0)
    v_add_u32 v46, v44, v45
    v_mov_b32 v47, v46
    s_nop 1
    v_add_u32_dpp v47, v47, v47 row_shr:1 row_mask:0xf bank_mask:0xf
    s_nop 1
    v_add_u32_dpp v47, v47, v47 row_shr:2 row_mask:0xf bank_mask:0xf
    s_nop 1
    v_add_u32_dpp v47, v47, v47 row_shr:4 row_mask:0xf bank_mask:0xf
    s_nop 1
    v_add_u32_dpp v47, v47, v47 row_shr:8 row_mask:0xf bank_mask:0xf
    s_nop 1
    v_add_u32_dpp v47, v47, v47 row_bcast:15 row_mask:0xa bank_mask:0xf
    s_nop 1
    v_add_u32_dpp v47, v47, v47 row_bcast:31 row_mask:0xc bank_mask:0xf
    v_sub_u32 v48, v47, v46
    v_add_u32 v49, v48, v44
    ds_write_b64 v6, v[48:49] offset:18432
    s_mov_b64 exec, s[14:15]
    s_cbranch_execz k1_b3
    ds_read_b32 v28, v28 offset:18432
    ds_read_b32 v29, v29 offset:18432
    ds_read_b32 v30, v30 offset:18432
    ds_read_b32 v31, v31 offset:18432
    ds_read_b32 v32, v32 offset:18432
    ds_read_b32 v33, v33 offset:18432
    ds_read_b32 v34, v34 offset:18432
    ds_read_b32 v35, v35 offset:18432
    s_waitcnt lgkmcnt(7)
    v_add_u32 v28, v28, v36
    v_lshlrev_b32 v36, 2, v28
    ds_write_b8 v28, v8 offset:12800
    s_waitcnt lgkmcnt(7)
    v_add_u32 v29, v29, v37
    v_lshlrev_b32 v37, 2, v29
    ds_write_b8 v29, v9 offset:12800
    s_waitcnt lgkmcnt(7)
    v_add_u32 v30, v30, v38
    v_lshlrev_b32 v38, 2, v30
    ds_write_b8 v30, v10 offset:12800
    s_waitcnt lgkmcnt(7)
    v_add_u32 v31, v31, v39
    v_lshlrev_b32 v39, 2, v31
    ds_write_b8 v31, v11 offset:12800
    s_waitcnt lgkmcnt(7)
    v_add_u32 v32, v32, v40
    v_lshlrev_b32 v40, 2, v32
    ds_write_b8 v32, v12 offset:12800
    s_waitcnt lgkmcnt(7)
    v_add_u32 v33, v33, v41
    v_lshlrev_b32 v41, 2, v33
    ds_write_b8 v33, v13 offset:12800
    s_waitcnt lgkmcnt(7)
    v_add_u32 v34, v34, v42
    v_lshlrev_b32 v42, 2, v34
    ds_write_b8 v34, v14 offset:12800
    s_waitcnt lgkmcnt(7)
    v_add_u32 v35, v35, v43
    v_lshlrev_b32 v43, 2, v35
    ds_write_b8 v35, v15 offset:12800
    v_lshlrev_b32 v1, 5, v0
    v_lshlrev_b32 v2, 4, v0
    s_barrier
    ds_read_b128 v[24:27], v2 offset:33792
    ds_read_b128 v[16:19], v1 offset:20480
    ds_read_b128 v[20:23], v1 offset:20496
    s_waitcnt lgkmcnt(1)
    v_lshl_or_b32 v16, v24, 16, v16
    ds_write_b32 v36, v16
    v_and_or_b32 v17, v24, s16, v17
    ds_write_b32 v37, v17
    v_lshl_or_b32 v18, v25, 16, v18
    ds_write_b32 v38, v18
    v_and_or_b32 v19, v25, s16, v19
    ds_write_b32 v39, v19
    s_waitcnt lgkmcnt(4)
    v_lshl_or_b32 v20, v26, 16, v20
    ds_write_b32 v40, v20
    v_and_or_b32 v21, v26, s16, v21
    ds_write_b32 v41, v21
    v_lshl_or_b32 v22, v27, 16, v22
    ds_write_b32 v42, v22
    v_and_or_b32 v23, v27, s16, v23
    ds_write_b32 v43, v23
    s_branch k1_b4
k1_b3:
    s_mov_b64 exec, -1
    s_mul_i32 s13, s3, 3200
    v_min_u32 v44, 255, v44
    v_min_u32 v45, 255, v45
    v_add_u32 v48, s13, v48
    v_add_u32 v49, s13, v49
    v_lshl_or_b32 v50, v44, 24, v48
    v_lshl_or_b32 v51, v45, 24, v49
    s_and_b32 s12, s3, 7
    s_lshl_b32 s12, s12, 7
    s_lshr_b32 s13, s3, 3
    s_lshl_b32 s13, s13, 2
    s_add_u32 s12, s12, s13
    s_add_u32 s12, s12, 11534336
    v_lshl_add_u32 v52, v6, 8, s12
    s_load_dwordx2 s[20:21], s[0:1], 0
    s_lshr_b32 s13, s3, 3
    s_mul_i32 s13, s13, 98
    v_lshrrev_b32 v53, 3, v6
    v_add_u32 v53, s13, v53
    v_add_u32 v54, 34, v53
    s_add_u32 s13, s3, 4
    s_and_b32 s13, s13, 7
    s_lshl_b32 s13, s13, 12
    v_lshrrev_b32 v55, 5, v53
    v_and_b32 v53, 31, v53
    v_lshlrev_b32 v53, 7, v53
    v_lshl_add_u32 v53, v55, 15, v53
    v_add_u32 v53, s13, v53
    v_lshrrev_b32 v55, 5, v54
    v_and_b32 v54, 31, v54
    v_lshlrev_b32 v54, 7, v54
    v_lshl_add_u32 v54, v55, 15, v54
    v_add_u32 v54, s13, v54
    s_mov_b32 s22, 3200000
    s_mov_b32 s23, 0x20000
    s_waitcnt lgkmcnt(0)
    s_waitcnt vmcnt(0)
    s_barrier
    buffer_load_dword v53, v53, s[20:23], 0 offen
    buffer_load_dword v54, v54, s[20:23], 0 offen
    global_store_dword v52, v50, s[10:11]
    global_store_dword v52, v51, s[10:11] offset:1024
k1_b4:
    s_mov_b64 exec, -1
    v_lshlrev_b32 v1, 4, v0
    s_mul_i32 s12, s3, 12800
    s_add_u32 s12, s12, 7340032
    s_mul_i32 s13, s3, 3200
    s_add_u32 s13, s13, 10612224
    v_add_u32 v2, s12, v1
    v_add_u32 v3, 8192, v2
    v_add_u32 v4, s13, v1
    v_cmp_gt_u32 vcc, 288, v0
    s_nop 1
    v_cndmask_b32 v3, v4, v3, vcc
    v_cmp_gt_u32 vcc, 488, v0
    s_waitcnt lgkmcnt(0)
    s_barrier
    ds_read_b128 v[8:11], v1
    ds_read_b128 v[12:15], v1 offset:8192
    s_waitcnt lgkmcnt(1)
    global_store_dwordx4 v2, v[8:11], s[10:11] sc1
    s_mov_b64 exec, vcc
    s_waitcnt lgkmcnt(0)
    global_store_dwordx4 v3, v[12:15], s[10:11] sc1
    s_endpgm
k1_wf:
    s_cmp_ge_u32 s3, 256
    s_cbranch_scc1 k1_end
    s_load_dwordx2 s[4:5], s[0:1], 32
    s_load_dwordx4 s[16:19], s[0:1], 48
    s_load_dwordx2 s[10:11], s[0:1], 88
    v_lshrrev_b32 v1, 6, v0
    v_and_b32 v2, 63, v0
    v_readfirstlane_b32 s12, v1
    v_and_b32 v3, 31, v0
    v_lshrrev_b32 v4, 5, v2
    v_lshlrev_b32 v3, 1, v3
    v_lshl_add_u32 v3, v4, 10, v3
    s_lshr_b32 s13, s12, 2
    s_lshl_b32 s13, s13, 6
    s_and_b32 s14, s12, 1
    s_lshl_b32 s14, s14, 12
    s_add_u32 s13, s13, s14
    v_add_u32 v3, s13, v3
    s_and_b32 s15, s3, 7
    s_lshl_b32 s15, s15, 7
    s_add_u32 s15, s15, 11534460
    v_lshl_add_u32 v5, v0, 10, s15
    v_mov_b32 v6, 0
    s_waitcnt lgkmcnt(0)
    s_cmp_ge_u32 s12, 2
    s_cbranch_scc1 k1_wf1
    global_store_dword v5, v6, s[10:11]
k1_wf1:
    s_cmp_lg_u32 s3, 250
    s_cbranch_scc1 k1_end
    s_bitcmp1_b32 s12, 1
    s_cselect_b32 s4, s18, s4
    s_cselect_b32 s5, s19, s5
    global_load_ushort v8, v3, s[4:5] offset:0
    global_load_ushort v9, v3, s[4:5] offset:128
    global_load_ushort v10, v3, s[4:5] offset:256
    global_load_ushort v11, v3, s[4:5] offset:384
    global_load_ushort v12, v3, s[4:5] offset:512
    global_load_ushort v13, v3, s[4:5] offset:640
    global_load_ushort v14, v3, s[4:5] offset:768
    global_load_ushort v15, v3, s[4:5] offset:896
    global_load_ushort v16, v3, s[4:5] offset:2048
    global_load_ushort v17, v3, s[4:5] offset:2176
    global_load_ushort v18, v3, s[4:5] offset:2304
    global_load_ushort v19, v3, s[4:5] offset:2432
    global_load_ushort v20, v3, s[4:5] offset:2560
    global_load_ushort v21, v3, s[4:5] offset:2688
    global_load_ushort v22, v3, s[4:5] offset:2816
    global_load_ushort v23, v3, s[4:5] offset:2944
    v_lshlrev_b32 v32, 1, v2
    global_load_ushort v33, v32, s[16:17]
    s_lshr_b32 s13, s12, 2
    s_mul_i32 s13, s13, 256
    s_lshl_b32 s14, s12, 11
    s_add_u32 s13, s13, s14
    s_add_u32 s13, s13, 11796480
    v_lshlrev_b32 v5, 4, v2
    v_add_u32 v5, s13, v5
    s_waitcnt vmcnt(0)
    v_lshl_or_b32 v24, v9, 16, v8
    v_lshl_or_b32 v25, v11, 16, v10
    v_lshl_or_b32 v26, v13, 16, v12
    v_lshl_or_b32 v27, v15, 16, v14
    v_lshl_or_b32 v28, v17, 16, v16
    v_lshl_or_b32 v29, v19, 16, v18
    v_lshl_or_b32 v30, v21, 16, v20
    v_lshl_or_b32 v31, v23, 16, v22
    global_store_dwordx4 v5, v[24:27], s[10:11]
    global_store_dwordx4 v5, v[28:31], s[10:11] offset:1024
    s_cmp_lg_u32 s12, 0
    s_cbranch_scc1 k1_end
    v_and_b32 v6, 31, v0
    v_lshlrev_b32 v6, 2, v6
    s_mov_b32 s13, 3211264
    v_mad_u32_u24 v7, v4, s13, v6
    v_add_u32 v7, 3203072, v7
    v_mov_b32 v8, 0x7c00
    global_store_dword v7, v8, s[10:11]
    s_movk_i32 s13, 8448
    v_mad_u32_u24 v6, v4, s13, v6
    v_add_u32 v6, 11804672, v6
    v_lshlrev_b32 v33, 16, v33
    v_mul_f32 v33, 3216550459, v33
    global_store_dword v6, v33, s[10:11]
    s_endpgm
k1_gemm:
    s_load_dwordx2 s[4:5], s[0:1], 0
    s_load_dwordx2 s[12:13], s[0:1], 40
    s_load_dwordx2 s[28:29], s[0:1], 64
    s_load_dwordx2 s[10:11], s[0:1], 88
    v_lshrrev_b32 v1, 6, v0
    v_and_b32 v2, 63, v0
    v_readfirstlane_b32 s16, v1
    s_lshr_b32 s17, s2, 3
    s_lshl_b32 s17, s17, 2
    s_lshr_b32 s22, s16, 1
    s_add_u32 s17, s17, s22
    s_lshl_b32 s17, s17, 3
    s_and_b32 s18, s2, 7
    s_add_u32 s17, s17, s18
    s_and_b32 s18, s16, 1
    s_lshl_b32 s19, s17, 12
    v_lshrrev_b32 v3, 4, v2
    v_xor_b32 v5, v3, v2
    v_and_b32 v5, 7, v5
    v_lshlrev_b32 v5, 4, v5
    v_and_b32 v4, 56, v2
    v_lshl_add_u32 v5, v4, 4, v5
    s_lshl_b32 s20, s18, 11
    s_add_u32 s20, s20, s19
    v_add_u32 v5, s20, v5
    v_xor_b32 v14, 64, v5
    s_lshl_b32 s21, s16, 11
    v_lshrrev_b32 v8, 2, v2
    v_and_b32 v9, 3, v2
    v_lshlrev_b32 v9, 4, v9
    v_lshl_add_u32 v8, v8, 7, v9
    s_lshl_b32 s20, s22, 11
    s_lshl_b32 s23, s18, 6
    s_add_u32 s20, s20, s23
    v_add_u32 v8, s20, v8
    s_mul_i32 s27, s18, 8256
    s_add_u32 s27, s27, 49152
    s_lshl_b32 s20, s22, 10
    s_add_u32 s20, s20, s27
    s_mov_b32 s6, 3200000
    s_mov_b32 s7, 0x20000
    s_movk_i32 s14, 0x2000
    s_mov_b32 s15, 0x20000
    s_movk_i32 s30, 0x2000
    s_mov_b32 s31, 0x20000
    s_mov_b32 m0, s21
    s_waitcnt lgkmcnt(0)
    buffer_load_dwordx4 v5, s[4:7], 0 offen  lds
    buffer_load_dwordx4 v14, s[4:7], 0 offen offset:1024  lds
    s_mov_b32 m0, s20
    s_add_u32 s20, s20, 4128
    buffer_load_dwordx4 v8, s[12:15], 0 offen lds
    s_mov_b32 m0, s20
    s_nop 0
    buffer_load_dwordx4 v8, s[28:31], 0 offen lds
    s_mov_b32 s23, 3216550459
    s_mov_b32 s24, 0x8000
    s_mov_b32 s25, 0xffff0000
    v_lshrrev_b32 v4, 5, v2
    v_and_b32 v7, 1, v3
    s_movk_i32 s20, 4128
    v_mul_u32_u24 v10, s20, v7
    v_bfe_u32 v6, v2, 2, 2
    v_lshl_add_u32 v6, v4, 3, v6
    v_lshl_add_u32 v10, v6, 6, v10
    v_lshrrev_b32 v9, 1, v9
    v_add3_u32 v10, v10, v9, s27
    s_lshl_b32 s21, s22, 12
    v_and_b32 v3, 31, v2
    v_bfe_u32 v5, v2, 1, 3
    v_xor_b32 v5, v5, v4
    v_lshlrev_b32 v5, 4, v5
    v_lshlrev_b32 v8, 7, v3
    v_add3_u32 v5, v5, v8, s21
    v_xor_b32 v6, 32, v5
    v_xor_b32 v7, 64, v5
    v_xor_b32 v14, 96, v5
    s_lshl_b32 s27, s16, 12
    s_add_u32 s27, s27, 16384
    v_and_b32 v15, 7, v2
    v_xor_b32 v15, v15, v4
    v_lshl_add_u32 v8, v15, 4, v8
    v_add_u32 v8, s27, v8
    v_lshrrev_b32 v1, 3, v2
    v_xor_b32 v15, v1, v2
    v_and_b32 v15, 7, v15
    v_lshlrev_b32 v15, 4, v15
    v_lshl_add_u32 v15, v1, 7, v15
    v_add_u32 v15, s27, v15
    s_mul_i32 s26, s18, 3211264
    s_add_u32 s26, s26, s19
    v_lshl_add_u32 v9, v2, 4, s26
    v_mov_b32 v12, 0
    v_mov_b32 v13, 0
    s_waitcnt vmcnt(0)
    s_barrier
    s_cmp_ge_u32 s17, 782
    s_cbranch_scc1 k1_end
    ds_read_b128 v[16:19], v5
    ds_read_b64_tr_b16 v[32:33], v10 offset:0
    ds_read_b64_tr_b16 v[34:35], v10 offset:256
    ds_read_b64_tr_b16 v[48:49], v10 offset:32
    ds_read_b64_tr_b16 v[50:51], v10 offset:288
    ds_read_b128 v[20:23], v6
    ds_read_b64_tr_b16 v[36:37], v10 offset:1024
    ds_read_b64_tr_b16 v[38:39], v10 offset:1280
    ds_read_b64_tr_b16 v[52:53], v10 offset:1056
    ds_read_b64_tr_b16 v[54:55], v10 offset:1312
    ds_read_b128 v[24:27], v7
    ds_read_b64_tr_b16 v[40:41], v10 offset:2048
    ds_read_b64_tr_b16 v[42:43], v10 offset:2304
    ds_read_b64_tr_b16 v[56:57], v10 offset:2080
    ds_read_b64_tr_b16 v[58:59], v10 offset:2336
    ds_read_b128 v[28:31], v14
    ds_read_b64_tr_b16 v[44:45], v10 offset:3072
    ds_read_b64_tr_b16 v[46:47], v10 offset:3328
    ds_read_b64_tr_b16 v[60:61], v10 offset:3104
    ds_read_b64_tr_b16 v[62:63], v10 offset:3360
    s_waitcnt lgkmcnt(15)
    v_mfma_f32_32x32x16_bf16 v[64:79], v[32:35], v[16:19], 0
    v_mfma_f32_32x32x16_bf16 v[80:95], v[48:51], v[16:19], 0
    s_waitcnt lgkmcnt(10)
    v_mfma_f32_32x32x16_bf16 v[64:79], v[36:39], v[20:23], v[64:79]
    v_mfma_f32_32x32x16_bf16 v[80:95], v[52:55], v[20:23], v[80:95]
    s_waitcnt lgkmcnt(5)
    v_mfma_f32_32x32x16_bf16 v[64:79], v[40:43], v[24:27], v[64:79]
    v_mfma_f32_32x32x16_bf16 v[80:95], v[56:59], v[24:27], v[80:95]
    s_waitcnt lgkmcnt(0)
    v_mfma_f32_32x32x16_bf16 v[64:79], v[44:47], v[28:31], v[64:79]
    v_mfma_f32_32x32x16_bf16 v[80:95], v[60:63], v[28:31], v[80:95]
    s_nop 9
    v_xor_b32 v5, 32, v8
    v_xor_b32 v6, 64, v8
    v_xor_b32 v7, 96, v8
    v_mul_f32 v64, s23, v64
    v_mul_f32 v65, s23, v65
    v_mul_f32 v66, s23, v66
    v_mul_f32 v67, s23, v67
    v_mul_f32 v68, s23, v68
    v_mul_f32 v69, s23, v69
    v_mul_f32 v70, s23, v70
    v_mul_f32 v71, s23, v71
    v_mul_f32 v80, s23, v80
    v_mul_f32 v81, s23, v81
    v_mul_f32 v82, s23, v82
    v_mul_f32 v83, s23, v83
    v_mul_f32 v84, s23, v84
    v_mul_f32 v85, s23, v85
    v_mul_f32 v86, s23, v86
    v_mul_f32 v87, s23, v87
    v_max3_f32 v12, |v64|, |v65|, v12
    v_max3_f32 v13, |v72|, |v73|, v13
    v_max3_f32 v12, |v66|, |v67|, v12
    v_max3_f32 v13, |v74|, |v75|, v13
    v_max3_f32 v12, |v68|, |v69|, v12
    v_max3_f32 v13, |v76|, |v77|, v13
    v_max3_f32 v12, |v70|, |v71|, v12
    v_max3_f32 v13, |v78|, |v79|, v13
    v_max3_f32 v12, |v80|, |v81|, v12
    v_max3_f32 v13, |v88|, |v89|, v13
    v_max3_f32 v12, |v82|, |v83|, v12
    v_max3_f32 v13, |v90|, |v91|, v13
    v_max3_f32 v12, |v84|, |v85|, v12
    v_max3_f32 v13, |v92|, |v93|, v13
    v_max3_f32 v12, |v86|, |v87|, v12
    v_max3_f32 v13, |v94|, |v95|, v13
    v_cvt_f16_f32 v64, v64
    v_sad_u32 v72, v72, v64, s24
    v_and_or_b32 v72, v72, s25, v64
    v_cvt_f16_f32 v65, v65
    v_sad_u32 v73, v73, v65, s24
    v_and_or_b32 v73, v73, s25, v65
    v_cvt_f16_f32 v66, v66
    v_sad_u32 v74, v74, v66, s24
    v_and_or_b32 v74, v74, s25, v66
    v_cvt_f16_f32 v67, v67
    v_sad_u32 v75, v75, v67, s24
    v_and_or_b32 v75, v75, s25, v67
    ds_write_b128 v8, v[72:75]
    v_cvt_f16_f32 v68, v68
    v_sad_u32 v76, v76, v68, s24
    v_and_or_b32 v76, v76, s25, v68
    v_cvt_f16_f32 v69, v69
    v_sad_u32 v77, v77, v69, s24
    v_and_or_b32 v77, v77, s25, v69
    v_cvt_f16_f32 v70, v70
    v_sad_u32 v78, v78, v70, s24
    v_and_or_b32 v78, v78, s25, v70
    v_cvt_f16_f32 v71, v71
    v_sad_u32 v79, v79, v71, s24
    v_and_or_b32 v79, v79, s25, v71
    ds_write_b128 v5, v[76:79]
    v_cvt_f16_f32 v80, v80
    v_sad_u32 v88, v88, v80, s24
    v_and_or_b32 v88, v88, s25, v80
    v_cvt_f16_f32 v81, v81
    v_sad_u32 v89, v89, v81, s24
    v_and_or_b32 v89, v89, s25, v81
    v_cvt_f16_f32 v82, v82
    v_sad_u32 v90, v90, v82, s24
    v_and_or_b32 v90, v90, s25, v82
    v_cvt_f16_f32 v83, v83
    v_sad_u32 v91, v91, v83, s24
    v_and_or_b32 v91, v91, s25, v83
    ds_write_b128 v6, v[88:91]
    v_cvt_f16_f32 v84, v84
    v_sad_u32 v92, v92, v84, s24
    v_and_or_b32 v92, v92, s25, v84
    v_cvt_f16_f32 v85, v85
    v_sad_u32 v93, v93, v85, s24
    v_and_or_b32 v93, v93, s25, v85
    v_cvt_f16_f32 v86, v86
    v_sad_u32 v94, v94, v86, s24
    v_and_or_b32 v94, v94, s25, v86
    v_cvt_f16_f32 v87, v87
    v_sad_u32 v95, v95, v87, s24
    v_and_or_b32 v95, v95, s25, v87
    ds_write_b128 v7, v[92:95]
    ds_read_b128 v[32:35], v15
    ds_read_b128 v[36:39], v15 offset:1024
    ds_read_b128 v[40:43], v15 offset:2048
    ds_read_b128 v[44:47], v15 offset:3072
    v_cmp_lt_f32 vcc, 0x476a6000, v12
    s_cbranch_vccnz k1_bad
    v_cmp_lt_f32 vcc, 0x53800000, v13
    s_cbranch_vccnz k1_bad
    v_cmp_le_f32 vcc, 0x30800000, v13
    s_cbranch_vccnz k1_good
    v_cmp_neq_f32 vcc, 0, v13
    s_cbranch_vccnz k1_bad
k1_good:
    s_waitcnt lgkmcnt(3)
    global_store_dwordx4 v9, v[32:35], s[10:11] offset:0 sc1
    s_waitcnt lgkmcnt(2)
    global_store_dwordx4 v9, v[36:39], s[10:11] offset:1024 sc1
    s_waitcnt lgkmcnt(1)
    global_store_dwordx4 v9, v[40:43], s[10:11] offset:2048 sc1
    s_waitcnt lgkmcnt(0)
    global_store_dwordx4 v9, v[44:47], s[10:11] offset:3072 sc1
    s_endpgm
k1_bad:
    v_mov_b32 v48, 0x7e00
    v_mov_b32 v49, 0x7e00
    v_mov_b32 v50, 0x7e00
    v_mov_b32 v51, 0x7e00
    global_store_dwordx4 v9, v[48:51], s[10:11] offset:0
    global_store_dwordx4 v9, v[48:51], s[10:11] offset:1024
    global_store_dwordx4 v9, v[48:51], s[10:11] offset:2048
    global_store_dwordx4 v9, v[48:51], s[10:11] offset:3072
k1_end:
    s_endpgm
.globl k2_kernel
.p2align 8
.type k2_kernel,@function
k2_kernel:
    s_cmp_ge_u32 s2, 256
    s_cbranch_scc1 k2_end
    s_load_dwordx2 s[10:11], s[0:1], 88
    s_load_dwordx2 s[12:13], s[0:1], 0
    s_load_dwordx2 s[16:17], s[0:1], 72
    v_lshrrev_b32 v2, 6, v0
    v_and_b32 v1, 63, v0
    v_readfirstlane_b32 s34, v2
    v_mov_b32 v116, 25024
    v_mov_b32 v117, 25024
    v_mov_b32 v118, 25024
    v_mov_b32 v119, 25024
    v_lshlrev_b32 v120, 4, v1
    v_lshl_add_u32 v120, v2, 12, v120
    ds_write_b128 v120, v[116:119] offset:1088
    ds_write_b128 v120, v[116:119] offset:2112
    s_and_b32 s32, s2, 3
    s_lshl_b32 s32, s32, 5
    s_lshr_b32 s3, s2, 3
    s_add_u32 s32, s32, s3
    s_bfe_u32 s33, s2, 0x10002
    v_lshrrev_b32 v3, 5, v1
    v_and_b32 v2, 31, v1
    s_mov_b32 s14, 3200000
    s_mov_b32 s15, 0x20000
    s_movk_i32 s22, 1024
    s_mov_b32 s23, 0x20000
    s_cmp_ge_u32 s34, 12
    s_cbranch_scc1 k2_t0
    v_and_b32 v4, 15, v1
    v_mad_u32_u24 v4, v3, 11, v4
    s_mul_i32 s4, s34, 22
    v_add_lshl_u32 v4, v4, s4, 2
    s_lshl_b32 s8, s32, 10
    s_add_u32 s8, s8, 11534336
    s_waitcnt lgkmcnt(0)
    s_add_u32 s20, s10, s8
    s_addc_u32 s21, s11, 0
    buffer_load_dword v8, v4, s[20:23], 0 offen
k2_t1:
    ds_write_b128 v120, v[116:119] offset:3136
    ds_write_b128 v120, v[116:119] offset:4160
    s_movk_i32 s5, 332
    s_mul_i32 s8, s34, 12
    v_mov_b32 v84, 1120
    v_add_u32 v121, s8, v1
    v_mad_u32_u24 v122, v121, s5, v84
    v_add_u32 v123, -764, v122
    v_lshrrev_b32 v123, 12, v123
    v_min_u32 v123, 15, v123
    v_cmp_eq_u32 s[48:49], s34, v123
    v_cmp_gt_u32 vcc, 196, v121
    v_mov_b32 v123, 0x100000
    v_mov_b32 v114, 0
    v_cndmask_b32 v123, v123, v122, vcc
    v_cmp_gt_u32 vcc, 228, v121
    v_mov_b32 v115, 0
    s_and_b64 exec, vcc, s[48:49]
    ds_write_b32 v122, v123 offset:324
    s_mov_b64 exec, -1
    s_cmp_lg_u32 s34, 0
    s_cbranch_scc1 k2_i1
    v_lshlrev_b32 v121, 3, v1
    ds_write_b64 v121, v[114:115]
k2_i1:
    s_add_u32 s24, s10, 7340032
    s_addc_u32 s25, s11, 0
    s_or_b32 s25, s25, 0x40000
    s_mov_b32 s26, 800000
    s_mov_b32 s27, 0x20000
    s_add_u32 s44, s10, 10616832
    s_addc_u32 s45, s11, 0
    s_mov_b32 s46, 800000
    s_mov_b32 s47, 0x20000
    v_mov_b32 v5, 4
    v_mov_b32 v113, 256
    s_cmp_ge_u32 s34, 12
    s_cbranch_scc1 k2_au
    v_not_b32 v124, v2
    v_lshlrev_b32 v124, 24, v124
    v_mov_b32 v6, 1440
    v_add_u32 v28, 196, v2
    v_mov_b32 v29, v28
    v_mov_b32 v30, v28
    v_mov_b32 v31, v28
    v_mov_b32 v32, v28
    v_mov_b32 v33, v28
    v_mov_b32 v34, v28
    v_mov_b32 v35, v28
    v_mov_b32 v36, v28
    v_mov_b32 v37, v28
    v_mov_b32 v38, v28
    v_mov_b32 v39, v28
    s_waitcnt lgkmcnt(0)
    s_barrier
    s_waitcnt vmcnt(0)
    v_and_b32 v9, 0xffffff, v8
    v_cmp_le_u32 vcc, 553648128, v8
    s_and_b32 s40, vcc_lo, 2047
    s_and_b32 s41, vcc_hi, 2047
    v_add_co_u32_dpp v7, vcc, v8, v124 row_newbcast:0 row_mask:0xf bank_mask:0xf
    v_add_u32_dpp v52, v9, v2 row_newbcast:0 row_mask:0xf bank_mask:0xf
    s_mov_b64 exec, vcc
    buffer_load_ubyte v28, v52, s[44:47], 0 offen
    buffer_load_dword v16, v52, s[24:27], 0 idxen
    s_mov_b64 exec, -1
    v_add_co_u32_dpp v7, vcc, v8, v124 row_newbcast:1 row_mask:0xf bank_mask:0xf
    v_add_u32_dpp v53, v9, v2 row_newbcast:1 row_mask:0xf bank_mask:0xf
    s_mov_b64 exec, vcc
    buffer_load_ubyte v29, v53, s[44:47], 0 offen
    buffer_load_dword v17, v53, s[24:27], 0 idxen
    s_mov_b64 exec, -1
    v_add_co_u32_dpp v7, vcc, v8, v124 row_newbcast:2 row_mask:0xf bank_mask:0xf
    v_add_u32_dpp v52, v9, v2 row_newbcast:2 row_mask:0xf bank_mask:0xf
    s_mov_b64 exec, vcc
    buffer_load_ubyte v30, v52, s[44:47], 0 offen
    buffer_load_dword v18, v52, s[24:27], 0 idxen
    s_mov_b64 exec, -1
    v_add_co_u32_dpp v7, vcc, v8, v124 row_newbcast:3 row_mask:0xf bank_mask:0xf
    v_add_u32_dpp v53, v9, v2 row_newbcast:3 row_mask:0xf bank_mask:0xf
    s_mov_b64 exec, vcc
    buffer_load_ubyte v31, v53, s[44:47], 0 offen
    buffer_load_dword v19, v53, s[24:27], 0 idxen
    s_mov_b64 exec, -1
    v_add_co_u32_dpp v7, vcc, v8, v124 row_newbcast:4 row_mask:0xf bank_mask:0xf
    v_add_u32_dpp v52, v9, v2 row_newbcast:4 row_mask:0xf bank_mask:0xf
    s_mov_b64 exec, vcc
    buffer_load_ubyte v32, v52, s[44:47], 0 offen
    buffer_load_dword v20, v52, s[24:27], 0 idxen
    s_mov_b64 exec, -1
    v_add_co_u32_dpp v7, vcc, v8, v124 row_newbcast:5 row_mask:0xf bank_mask:0xf
    v_add_u32_dpp v53, v9, v2 row_newbcast:5 row_mask:0xf bank_mask:0xf
    s_mov_b64 exec, vcc
    buffer_load_ubyte v33, v53, s[44:47], 0 offen
    buffer_load_dword v21, v53, s[24:27], 0 idxen
    s_mov_b64 exec, -1
    v_add_co_u32_dpp v7, vcc, v8, v124 row_newbcast:6 row_mask:0xf bank_mask:0xf
    v_add_u32_dpp v52, v9, v2 row_newbcast:6 row_mask:0xf bank_mask:0xf
    s_mov_b64 exec, vcc
    buffer_load_ubyte v34, v52, s[44:47], 0 offen
    buffer_load_dword v22, v52, s[24:27], 0 idxen
    s_mov_b64 exec, -1
    v_add_co_u32_dpp v7, vcc, v8, v124 row_newbcast:7 row_mask:0xf bank_mask:0xf
    v_add_u32_dpp v53, v9, v2 row_newbcast:7 row_mask:0xf bank_mask:0xf
    s_mov_b64 exec, vcc
    buffer_load_ubyte v35, v53, s[44:47], 0 offen
    buffer_load_dword v23, v53, s[24:27], 0 idxen
    s_mov_b64 exec, -1
    v_add_co_u32_dpp v7, vcc, v8, v124 row_newbcast:8 row_mask:0xf bank_mask:0xf
    v_add_u32_dpp v52, v9, v2 row_newbcast:8 row_mask:0xf bank_mask:0xf
    s_mov_b64 exec, vcc
    buffer_load_ubyte v36, v52, s[44:47], 0 offen
    buffer_load_dword v24, v52, s[24:27], 0 idxen
    s_mov_b64 exec, -1
    v_add_co_u32_dpp v7, vcc, v8, v124 row_newbcast:9 row_mask:0xf bank_mask:0xf
    v_add_u32_dpp v53, v9, v2 row_newbcast:9 row_mask:0xf bank_mask:0xf
    s_mov_b64 exec, vcc
    buffer_load_ubyte v37, v53, s[44:47], 0 offen
    buffer_load_dword v25, v53, s[24:27], 0 idxen
    s_mov_b64 exec, -1
    v_add_co_u32_dpp v7, vcc, v8, v124 row_newbcast:10 row_mask:0xf bank_mask:0xf
    v_add_u32_dpp v52, v9, v2 row_newbcast:10 row_mask:0xf bank_mask:0xf
    s_mov_b64 exec, vcc
    buffer_load_ubyte v38, v52, s[44:47], 0 offen
    buffer_load_dword v26, v52, s[24:27], 0 idxen
    s_mov_b64 exec, -1
    s_cmp_eq_u64 s[40:41], 0
    s_cbranch_scc1 k2_r2_done
    s_mov_b32 s48, 0
k2_r2:
    s_ff1_i32_b64 s4, s[40:41]
    s_bitset0_b64 s[40:41], s4
    v_readlane_b32 s8, v8, s4
    s_mov_b64 exec, -1
    s_lshr_b32 s9, s8, 24
    s_sub_u32 s9, s9, 32
    s_and_b32 s8, s8, 0xffffff
    s_add_u32 s8, s8, 32
    s_sub_u32 s8, s8, s48
    v_add_u32 v54, s8, v1
    s_bfm_b64 s[50:51], s9, s48
    s_add_u32 s48, s48, s9
    s_cmp_gt_u32 s48, 63
    s_cbranch_scc1 k2_r2_over
    s_mov_b64 exec, s[50:51]
    buffer_load_ubyte v39, v54, s[44:47], 0 offen
    buffer_load_dword v27, v54, s[24:27], 0 idxen
    s_cmp_lg_u64 s[40:41], 0
    s_cbranch_scc1 k2_r2
k2_r2_done:
    s_mov_b64 exec, -1
    s_waitcnt vmcnt(16)
    v_mad_u32_u24 v28, v28, s5, v6
    v_mad_u32_u24 v29, v29, s5, v6
    v_mad_u32_u24 v30, v30, s5, v6
    ds_add_rtn_u32 v40, v28, v5 offset:4
    ds_add_rtn_u32 v41, v29, v5 offset:4
    ds_add_rtn_u32 v42, v30, v5 offset:4
    s_waitcnt vmcnt(10)
    v_mad_u32_u24 v31, v31, s5, v6
    v_mad_u32_u24 v32, v32, s5, v6
    v_mad_u32_u24 v33, v33, s5, v6
    ds_add_rtn_u32 v43, v31, v5 offset:4
    ds_add_rtn_u32 v44, v32, v5 offset:4
    ds_add_rtn_u32 v45, v33, v5 offset:4
    s_waitcnt lgkmcnt(3)
    v_min_u32 v40, v40, v28
    v_min_u32 v41, v41, v29
    v_min_u32 v42, v42, v30
    ds_write_b32 v40, v16
    ds_write_b32 v41, v17
    ds_write_b32 v42, v18
    s_waitcnt vmcnt(4)
    v_mad_u32_u24 v34, v34, s5, v6
    v_mad_u32_u24 v35, v35, s5, v6
    v_mad_u32_u24 v36, v36, s5, v6
    ds_add_rtn_u32 v46, v34, v5 offset:4
    ds_add_rtn_u32 v47, v35, v5 offset:4
    ds_add_rtn_u32 v48, v36, v5 offset:4
    s_waitcnt lgkmcnt(3)
    v_min_u32 v43, v43, v31
    v_min_u32 v44, v44, v32
    v_min_u32 v45, v45, v33
    ds_write_b32 v43, v19
    ds_write_b32 v44, v20
    ds_write_b32 v45, v21
    s_waitcnt vmcnt(0)
    v_mad_u32_u24 v37, v37, s5, v6
    v_mad_u32_u24 v38, v38, s5, v6
    v_mad_u32_u24 v39, v39, s5, v6
    ds_add_rtn_u32 v49, v37, v5 offset:4
    ds_add_rtn_u32 v50, v38, v5 offset:4
    ds_add_rtn_u32 v51, v39, v5 offset:4
    s_waitcnt lgkmcnt(3)
    v_min_u32 v46, v46, v34
    v_min_u32 v47, v47, v35
    v_min_u32 v48, v48, v36
    ds_write_b32 v46, v22
    ds_write_b32 v47, v23
    ds_write_b32 v48, v24
    s_waitcnt lgkmcnt(0)
    v_min_u32 v49, v49, v37
    v_min_u32 v50, v50, v38
    v_min_u32 v51, v51, v39
    ds_write_b32 v49, v25
    ds_write_b32 v50, v26
    ds_write_b32 v51, v27
    s_mul_i32 s8, s33, 3211264
    s_add_u32 s42, s10, s8
    s_addc_u32 s43, s11, 0
    s_mul_i32 s4, s3, 12
    s_add_u32 s4, s4, s34
    s_mul_i32 s4, s4, 65
    v_add_lshl_u32 v115, v1, s4, 7
    s_mov_b32 exec_lo, 0xffff
    s_mov_b32 exec_hi, 0x0
    global_load_dword v114, v115, s[42:43]
    s_mov_b64 exec, -1
k2_au_done:
    s_mov_b32 s18, 3200000
    s_mov_b32 s19, 0x20000
    s_mov_b32 s28, s42
    s_or_b32 s29, s43, 0x800000
    s_mov_b32 s30, 25088
    s_mov_b32 s31, 0x20000
    s_mov_b32 s36, 562036736
    s_mov_b32 s37, 562036736
    s_mov_b32 s38, 1401305021
    s_mov_b32 s39, 1401305021
    s_waitcnt lgkmcnt(0)
    s_barrier
    s_cmp_lg_u32 s34, 15
    s_cbranch_scc1 k2_nosort
    s_setprio 3
    v_mul_u32_u24 v9, s5, v1
    ds_read_b32 v12, v9 offset:1444
    ds_read_b32 v13, v9 offset:22692
    ds_read_b32 v14, v9 offset:43940
    s_mov_b64 exec, 15
    ds_read_b32 v15, v9 offset:65188
    s_mov_b64 exec, -1
    v_lshlrev_b32 v11, 2, v1
    v_mov_b32 v10, 252
    v_mov_b32 v30, 1
    v_mov_b32 v32, 0
    v_add_u32 v36, 1116, v9
    v_add_u32 v37, 22364, v9
    v_add_u32 v38, 43612, v9
    v_add_u32 v39, 64860, v9
    s_waitcnt lgkmcnt(3)
    v_sub_u32 v12, v12, v36
    v_max_u32 v32, v32, v12
    v_min_u32 v12, 324, v12
    v_lshrrev_b32 v12, 3, v12
    v_lshlrev_b32 v16, 2, v12
    v_sub_u32 v16, v10, v16
    ds_add_rtn_u32 v24, v16, v30 offset:0
    s_waitcnt lgkmcnt(3)
    v_sub_u32 v13, v13, v37
    v_max_u32 v32, v32, v13
    v_min_u32 v13, 324, v13
    v_lshrrev_b32 v13, 3, v13
    v_lshlrev_b32 v17, 2, v13
    v_sub_u32 v17, v10, v17
    ds_add_rtn_u32 v25, v17, v30 offset:0
    s_waitcnt lgkmcnt(3)
    v_sub_u32 v14, v14, v38
    v_max_u32 v32, v32, v14
    v_min_u32 v14, 324, v14
    v_lshrrev_b32 v14, 3, v14
    v_lshlrev_b32 v18, 2, v14
    v_sub_u32 v18, v10, v18
    ds_add_rtn_u32 v26, v18, v30 offset:0
    s_mov_b64 exec, 15
    s_waitcnt lgkmcnt(3)
    v_sub_u32 v15, v15, v39
    v_max_u32 v32, v32, v15
    v_min_u32 v15, 324, v15
    v_lshrrev_b32 v15, 3, v15
    v_lshlrev_b32 v19, 2, v15
    v_sub_u32 v19, v10, v19
    ds_add_rtn_u32 v27, v19, v30 offset:0
    s_mov_b64 exec, -1
    ds_read_b32 v28, v11 offset:0
    v_cmp_lt_u32 vcc, 324, v32
    s_cbranch_vccz k2_s1
    ds_write_b32 v113, v5
k2_s1:
    v_add_u32 v33, 0, v1
    v_lshl_or_b32 v33, v12, 16, v33
    v_add_u32 v34, 64, v1
    v_lshl_or_b32 v34, v13, 16, v34
    v_add_u32 v35, 128, v1
    v_lshl_or_b32 v35, v14, 16, v35
    v_add_u32 v36, 192, v1
    v_lshl_or_b32 v36, v15, 16, v36
    s_waitcnt lgkmcnt(0)
    v_mov_b32 v29, v28
    s_nop 1
    v_add_u32_dpp v29, v29, v29 row_shr:1 row_mask:0xf bank_mask:0xf
    s_nop 1
    v_add_u32_dpp v29, v29, v29 row_shr:2 row_mask:0xf bank_mask:0xf
    s_nop 1
    v_add_u32_dpp v29, v29, v29 row_shr:4 row_mask:0xf bank_mask:0xf
    s_nop 1
    v_add_u32_dpp v29, v29, v29 row_shr:8 row_mask:0xf bank_mask:0xf
    s_nop 1
    v_add_u32_dpp v29, v29, v29 row_bcast:15 row_mask:0xa bank_mask:0xf
    s_nop 1
    v_add_u32_dpp v29, v29, v29 row_bcast:31 row_mask:0xc bank_mask:0xf
    v_sub_u32 v29, v29, v28
    ds_bpermute_b32 v20, v16, v29
    ds_bpermute_b32 v21, v17, v29
    ds_bpermute_b32 v22, v18, v29
    ds_bpermute_b32 v23, v19, v29
    s_waitcnt lgkmcnt(3)
    v_add_lshl_u32 v20, v20, v24, 2
    ds_write_b32 v20, v33 offset:272
    s_waitcnt lgkmcnt(3)
    v_add_lshl_u32 v21, v21, v25, 2
    ds_write_b32 v21, v34 offset:272
    s_waitcnt lgkmcnt(3)
    v_add_lshl_u32 v22, v22, v26, 2
    ds_write_b32 v22, v35 offset:272
    s_mov_b64 exec, 15
    s_waitcnt lgkmcnt(3)
    v_add_lshl_u32 v23, v23, v27, 2
    ds_write_b32 v23, v36 offset:272
    s_mov_b64 exec, -1
k2_nosort:
    v_and_b32 v51, 7, v1
    v_lshlrev_b32 v51, 4, v51
    v_add_u32 v82, 102528, v51
    ds_read_b128 v[4:7], v82
    s_mov_b32 s65, 0xffff0000
    v_mov_b32 v84, 1120
    v_lshrrev_b32 v82, 1, v51
    s_lshl_b32 s4, s33, 6
    v_add_u32 v82, s4, v82
    v_mov_b32 v53, v51
    v_mov_b32 v89, v51
    v_mov_b32 v91, v51
    v_mov_b32 v93, v51
    v_mov_b32 v95, v51
    v_add_u32 v81, 102784, v51
    v_mov_b32 v48, 0
    v_mov_b32 v49, 0
    v_lshrrev_b32 v83, 3, v1
    s_lshl_b32 s66, s32, 7
    v_add_u32 v82, s66, v82
    s_movk_i32 s66, 144
    s_mov_b32 s54, 0
    s_lshl_b32 s4, s34, 5
    s_add_u32 s4, s4, 288
    v_lshl_add_u32 v80, v83, 2, s4
    s_cmp_lt_u32 s34, 12
    s_cbranch_scc1 k2_c1
    s_lshl_b32 s4, s34, 2
    s_add_u32 s4, s4, 224
    v_mov_b32 v80, s4
    s_mov_b32 s38, 1376139197
    s_mov_b32 s39, 1376139197
k2_c1:
    s_setprio 3
    s_waitcnt lgkmcnt(0)
    s_barrier
    ds_read_b64 v[86:87], v113
    ds_read_b32 v80, v80
    s_waitcnt lgkmcnt(1)
    v_or_b32 v85, v86, v87
    v_readfirstlane_b32 s64, v87
    v_cmp_ne_u32 vcc, 0, v85
    s_cbranch_vccnz k2_mb
    s_branch k2_group1
k2_group:
    ds_read_b32 v80, v80
k2_group1:
    s_waitcnt lgkmcnt(0)
    v_readfirstlane_b32 s40, v80
    v_and_b32 v80, 0xffff, v80
    v_mad_u32_u24 v54, s5, v80, v84
    s_lshr_b32 s40, s40, 16
    s_cmp_lt_u32 s34, 12
    s_cbranch_scc1 k2_go
    s_add_u32 s40, s40, 7
    s_lshr_b32 s40, s40, 3
    s_max_u32 s40, s40, 2
    s_lshl_b32 s41, s40, 3
    v_mad_u32_u24 v54, v83, s41, v54
k2_go:
    ds_read_u16 v50, v54 offset:0
    ds_read_u16 v52, v54 offset:4
    ds_read_u16 v88, v54 offset:8
    ds_read_u16 v90, v54 offset:12
    v_mad_u32_u24 v55, v80, s66, v81
    v_lshl_add_u32 v58, v80, 14, v82
    ds_read_b128 v[8:11], v55
    buffer_load_dwordx2 v[56:57], v58, s[12:15], 0 offen
    s_max_u32 s40, s40, 2
    s_mul_i32 s4, s40, 43691
    s_lshr_b32 s4, s4, 17
    s_mul_i32 s41, s4, 3
    s_sub_u32 s67, s40, s41
    s_mov_b32 s40, s4
    s_cmp_gt_u32 s40, 2
    s_cselect_b32 s41, 2, 0
    s_cmp_eq_u32 s54, 0
    s_cselect_b32 s41, 0, s41
    v_mov_b64 v[16:17], s[38:39]
    v_mov_b64 v[18:19], s[38:39]
    v_mov_b64 v[20:21], 0
    v_mov_b64 v[22:23], 0
    s_waitcnt lgkmcnt(1)
    s_cmp_eq_u32 s67, 1
    s_cbranch_scc1 k2_e1
    s_cmp_eq_u32 s67, 0
    s_cbranch_scc1 k2_e2
    buffer_load_dwordx4 v[24:27], v[50:51], s[28:31], 0 idxen offen
    buffer_load_dwordx4 v[28:31], v[52:53], s[28:31], 0 idxen offen
    buffer_load_dwordx4 v[32:35], v[88:89], s[28:31], 0 idxen offen
    buffer_load_dwordx4 v[36:39], v[90:91], s[28:31], 0 idxen offen
    ds_read_u16 v50, v54 offset:16
    ds_read_u16 v52, v54 offset:20
    ds_read_u16_d16_hi v48, v54 offset:2
    ds_read_u16_d16_hi v49, v54 offset:6
    s_cmp_eq_u32 s40, 0
    s_cbranch_scc1 k2_e0t
    s_cmp_lg_u32 s64, 0
    s_cbranch_scc1 k2_loopB0
    s_branch k2_loopA0
k2_e1:
    buffer_load_dwordx4 v[32:35], v[50:51], s[28:31], 0 idxen offen
    buffer_load_dwordx4 v[36:39], v[52:53], s[28:31], 0 idxen offen
    buffer_load_dwordx4 v[40:43], v[88:89], s[28:31], 0 idxen offen
    buffer_load_dwordx4 v[44:47], v[90:91], s[28:31], 0 idxen offen
    ds_read_u16 v50, v54 offset:16
    ds_read_u16 v52, v54 offset:20
    ds_read_u16_d16_hi v48, v54 offset:2
    ds_read_u16_d16_hi v49, v54 offset:6
    v_subrev_u32 v54, 8, v54
    s_cmp_lg_u32 s64, 0
    s_cbranch_scc1 k2_loopB1
    s_branch k2_loopA1
k2_e2:
    buffer_load_dwordx4 v[40:43], v[50:51], s[28:31], 0 idxen offen
    buffer_load_dwordx4 v[44:47], v[52:53], s[28:31], 0 idxen offen
    buffer_load_dwordx4 v[24:27], v[88:89], s[28:31], 0 idxen offen
    buffer_load_dwordx4 v[28:31], v[90:91], s[28:31], 0 idxen offen
    ds_read_u16 v50, v54 offset:16
    ds_read_u16 v52, v54 offset:20
    ds_read_u16_d16_hi v48, v54 offset:2
    ds_read_u16_d16_hi v49, v54 offset:6
    v_subrev_u32 v54, 16, v54
    s_cmp_lg_u32 s64, 0
    s_cbranch_scc1 k2_loopB2
    s_branch k2_loopA2
k2_e0t:
    s_cmp_lg_u32 s64, 0
    s_cbranch_scc1 k2_tailB
    s_branch k2_tailA
    .p2align 6
k2_loopA0:
    s_waitcnt vmcnt(2) lgkmcnt(0)
    buffer_load_dwordx4 v[40:43], v[50:51], s[28:31], 0 idxen offen
    buffer_load_dwordx4 v[44:47], v[52:53], s[28:31], 0 idxen offen
    v_fma_mix_f32 v60, v48, v4, v24 op_sel_hi:[0,0,1]
    v_fma_mix_f32 v61, v48, v5, v25 op_sel_hi:[0,0,1]
    v_fma_mix_f32 v62, v48, v6, v26 op_sel_hi:[0,0,1]
    v_fma_mix_f32 v63, v48, v7, v27 op_sel_hi:[0,0,1]
    v_fma_mix_f32 v64, v49, v4, v28 op_sel_hi:[0,0,1]
    v_fma_mix_f32 v65, v49, v5, v29 op_sel_hi:[0,0,1]
    v_fma_mix_f32 v66, v49, v6, v30 op_sel_hi:[0,0,1]
    v_fma_mix_f32 v67, v49, v7, v31 op_sel_hi:[0,0,1]
    ds_read_u16 v50, v54 offset:24
    ds_read_u16 v52, v54 offset:28
    ds_read_u16_d16_hi v48, v54 offset:10
    ds_read_u16_d16_hi v49, v54 offset:14
    v_exp_f32 v60, v60
    v_exp_f32 v61, v61
    v_exp_f32 v64, v64
    v_exp_f32 v65, v65
    v_exp_f32 v62, v62
    v_exp_f32 v63, v63
    v_exp_f32 v66, v66
    v_exp_f32 v67, v67
    v_pk_fma_f32 v[60:61], v[60:61], v[8:9], s[36:37] clamp
    v_pk_fma_f32 v[64:65], v[64:65], v[8:9], s[36:37] clamp
    v_pk_fma_f32 v[62:63], v[62:63], v[10:11], s[36:37] clamp
    v_pk_fma_f32 v[66:67], v[66:67], v[10:11], s[36:37] clamp
    v_pk_mul_f32 v[68:69], v[60:61], v[64:65]
    v_pk_mul_f32 v[70:71], v[62:63], v[66:67]
    v_pk_mul_f32 v[76:77], v[64:65], v[24:25]
    v_rcp_f32 v68, v68
    v_rcp_f32 v69, v69
    v_pk_mul_f32 v[78:79], v[66:67], v[26:27]
    v_rcp_f32 v70, v70
    v_rcp_f32 v71, v71
    v_pk_add_f32 v[72:73], v[60:61], v[64:65]
    v_pk_add_f32 v[74:75], v[62:63], v[66:67]
    v_pk_fma_f32 v[76:77], v[60:61], v[28:29], v[76:77]
    v_pk_fma_f32 v[78:79], v[62:63], v[30:31], v[78:79]
    v_pk_fma_f32 v[16:17], v[72:73], v[68:69], v[16:17]
    v_pk_fma_f32 v[18:19], v[74:75], v[70:71], v[18:19]
    v_pk_fma_f32 v[20:21], v[76:77], v[68:69], v[20:21]
    v_pk_fma_f32 v[22:23], v[78:79], v[70:71], v[22:23]
k2_loopA1:
    s_waitcnt vmcnt(2) lgkmcnt(0)
    buffer_load_dwordx4 v[24:27], v[50:51], s[28:31], 0 idxen offen
    buffer_load_dwordx4 v[28:31], v[52:53], s[28:31], 0 idxen offen
    v_fma_mix_f32 v60, v48, v4, v32 op_sel_hi:[0,0,1]
    v_fma_mix_f32 v61, v48, v5, v33 op_sel_hi:[0,0,1]
    v_fma_mix_f32 v62, v48, v6, v34 op_sel_hi:[0,0,1]
    v_fma_mix_f32 v63, v48, v7, v35 op_sel_hi:[0,0,1]
    v_fma_mix_f32 v64, v49, v4, v36 op_sel_hi:[0,0,1]
    v_fma_mix_f32 v65, v49, v5, v37 op_sel_hi:[0,0,1]
    v_fma_mix_f32 v66, v49, v6, v38 op_sel_hi:[0,0,1]
    v_fma_mix_f32 v67, v49, v7, v39 op_sel_hi:[0,0,1]
    ds_read_u16 v50, v54 offset:32
    ds_read_u16 v52, v54 offset:36
    ds_read_u16_d16_hi v48, v54 offset:18
    ds_read_u16_d16_hi v49, v54 offset:22
    v_exp_f32 v60, v60
    v_exp_f32 v61, v61
    v_exp_f32 v64, v64
    v_exp_f32 v65, v65
    v_exp_f32 v62, v62
    v_exp_f32 v63, v63
    v_exp_f32 v66, v66
    v_exp_f32 v67, v67
    v_pk_fma_f32 v[60:61], v[60:61], v[8:9], s[36:37] clamp
    v_pk_fma_f32 v[64:65], v[64:65], v[8:9], s[36:37] clamp
    v_pk_fma_f32 v[62:63], v[62:63], v[10:11], s[36:37] clamp
    v_pk_fma_f32 v[66:67], v[66:67], v[10:11], s[36:37] clamp
    v_pk_mul_f32 v[68:69], v[60:61], v[64:65]
    v_pk_mul_f32 v[70:71], v[62:63], v[66:67]
    v_pk_mul_f32 v[76:77], v[64:65], v[32:33]
    v_rcp_f32 v68, v68
    v_rcp_f32 v69, v69
    v_pk_mul_f32 v[78:79], v[66:67], v[34:35]
    v_rcp_f32 v70, v70
    v_rcp_f32 v71, v71
    v_pk_add_f32 v[72:73], v[60:61], v[64:65]
    v_pk_add_f32 v[74:75], v[62:63], v[66:67]
    v_pk_fma_f32 v[76:77], v[60:61], v[36:37], v[76:77]
    v_pk_fma_f32 v[78:79], v[62:63], v[38:39], v[78:79]
    v_pk_fma_f32 v[16:17], v[72:73], v[68:69], v[16:17]
    v_pk_fma_f32 v[18:19], v[74:75], v[70:71], v[18:19]
    v_pk_fma_f32 v[20:21], v[76:77], v[68:69], v[20:21]
    v_pk_fma_f32 v[22:23], v[78:79], v[70:71], v[22:23]
k2_loopA2:
    s_waitcnt vmcnt(2) lgkmcnt(0)
    buffer_load_dwordx4 v[32:35], v[50:51], s[28:31], 0 idxen offen
    buffer_load_dwordx4 v[36:39], v[52:53], s[28:31], 0 idxen offen
    v_fma_mix_f32 v60, v48, v4, v40 op_sel_hi:[0,0,1]
    v_fma_mix_f32 v61, v48, v5, v41 op_sel_hi:[0,0,1]
    v_fma_mix_f32 v62, v48, v6, v42 op_sel_hi:[0,0,1]
    v_fma_mix_f32 v63, v48, v7, v43 op_sel_hi:[0,0,1]
    v_fma_mix_f32 v64, v49, v4, v44 op_sel_hi:[0,0,1]
    v_fma_mix_f32 v65, v49, v5, v45 op_sel_hi:[0,0,1]
    v_fma_mix_f32 v66, v49, v6, v46 op_sel_hi:[0,0,1]
    v_fma_mix_f32 v67, v49, v7, v47 op_sel_hi:[0,0,1]
    ds_read_u16 v50, v54 offset:40
    ds_read_u16 v52, v54 offset:44
    ds_read_u16_d16_hi v48, v54 offset:26
    ds_read_u16_d16_hi v49, v54 offset:30
    v_exp_f32 v60, v60
    v_exp_f32 v61, v61
    v_exp_f32 v64, v64
    v_exp_f32 v65, v65
    v_exp_f32 v62, v62
    v_exp_f32 v63, v63
    v_exp_f32 v66, v66
    v_exp_f32 v67, v67
    v_pk_fma_f32 v[60:61], v[60:61], v[8:9], s[36:37] clamp
    v_pk_fma_f32 v[64:65], v[64:65], v[8:9], s[36:37] clamp
    v_pk_fma_f32 v[62:63], v[62:63], v[10:11], s[36:37] clamp
    v_pk_fma_f32 v[66:67], v[66:67], v[10:11], s[36:37] clamp
    v_pk_mul_f32 v[68:69], v[60:61], v[64:65]
    v_pk_mul_f32 v[70:71], v[62:63], v[66:67]
    v_pk_mul_f32 v[76:77], v[64:65], v[40:41]
    v_rcp_f32 v68, v68
    v_rcp_f32 v69, v69
    v_pk_mul_f32 v[78:79], v[66:67], v[42:43]
    v_rcp_f32 v70, v70
    v_rcp_f32 v71, v71
    v_pk_add_f32 v[72:73], v[60:61], v[64:65]
    v_pk_add_f32 v[74:75], v[62:63], v[66:67]
    v_pk_fma_f32 v[76:77], v[60:61], v[44:45], v[76:77]
    v_pk_fma_f32 v[78:79], v[62:63], v[46:47], v[78:79]
    v_pk_fma_f32 v[16:17], v[72:73], v[68:69], v[16:17]
    v_pk_fma_f32 v[18:19], v[74:75], v[70:71], v[18:19]
    v_pk_fma_f32 v[20:21], v[76:77], v[68:69], v[20:21]
    v_pk_fma_f32 v[22:23], v[78:79], v[70:71], v[22:23]
    v_add_u32 v54, 24, v54
    s_sub_u32 s40, s40, 1
    s_cmp_lg_u32 s40, s41
    s_cbranch_scc1 k2_loopA0
    s_cmp_eq_u32 s41, 0
    s_cbranch_scc1 k2_tailA
    s_mov_b32 s41, 0
    s_setprio 1
    s_branch k2_loopA0
k2_tailA:
    s_cmp_eq_u32 s54, 0
    s_cbranch_scc1 k2_tlA
    s_setprio 0
k2_tlA:
    s_waitcnt vmcnt(2) lgkmcnt(0)
    v_fma_mix_f32 v60, v48, v4, v24 op_sel_hi:[0,0,1]
    v_fma_mix_f32 v61, v48, v5, v25 op_sel_hi:[0,0,1]
    v_fma_mix_f32 v62, v48, v6, v26 op_sel_hi:[0,0,1]
    v_fma_mix_f32 v63, v48, v7, v27 op_sel_hi:[0,0,1]
    v_fma_mix_f32 v64, v49, v4, v28 op_sel_hi:[0,0,1]
    v_fma_mix_f32 v65, v49, v5, v29 op_sel_hi:[0,0,1]
    v_fma_mix_f32 v66, v49, v6, v30 op_sel_hi:[0,0,1]
    v_fma_mix_f32 v67, v49, v7, v31 op_sel_hi:[0,0,1]
    ds_read_u16_d16_hi v48, v54 offset:10
    ds_read_u16_d16_hi v49, v54 offset:14
    v_exp_f32 v60, v60
    v_exp_f32 v61, v61
    v_exp_f32 v64, v64
    v_exp_f32 v65, v65
    v_exp_f32 v62, v62
    v_exp_f32 v63, v63
    v_exp_f32 v66, v66
    v_exp_f32 v67, v67
    v_pk_fma_f32 v[60:61], v[60:61], v[8:9], s[36:37] clamp
    v_pk_fma_f32 v[64:65], v[64:65], v[8:9], s[36:37] clamp
    v_pk_fma_f32 v[62:63], v[62:63], v[10:11], s[36:37] clamp
    v_pk_fma_f32 v[66:67], v[66:67], v[10:11], s[36:37] clamp
    v_pk_mul_f32 v[68:69], v[60:61], v[64:65]
    v_pk_mul_f32 v[70:71], v[62:63], v[66:67]
    v_pk_mul_f32 v[76:77], v[64:65], v[24:25]
    v_rcp_f32 v68, v68
    v_rcp_f32 v69, v69
    v_pk_mul_f32 v[78:79], v[66:67], v[26:27]
    v_rcp_f32 v70, v70
    v_rcp_f32 v71, v71
    v_pk_add_f32 v[72:73], v[60:61], v[64:65]
    v_pk_add_f32 v[74:75], v[62:63], v[66:67]
    v_pk_fma_f32 v[76:77], v[60:61], v[28:29], v[76:77]
    v_pk_fma_f32 v[78:79], v[62:63], v[30:31], v[78:79]
    v_pk_fma_f32 v[16:17], v[72:73], v[68:69], v[16:17]
    v_pk_fma_f32 v[18:19], v[74:75], v[70:71], v[18:19]
    v_pk_fma_f32 v[20:21], v[76:77], v[68:69], v[20:21]
    v_pk_fma_f32 v[22:23], v[78:79], v[70:71], v[22:23]
    s_waitcnt vmcnt(0) lgkmcnt(0)
    v_fma_mix_f32 v60, v48, v4, v32 op_sel_hi:[0,0,1]
    v_fma_mix_f32 v61, v48, v5, v33 op_sel_hi:[0,0,1]
    v_fma_mix_f32 v62, v48, v6, v34 op_sel_hi:[0,0,1]
    v_fma_mix_f32 v63, v48, v7, v35 op_sel_hi:[0,0,1]
    v_fma_mix_f32 v64, v49, v4, v36 op_sel_hi:[0,0,1]
    v_fma_mix_f32 v65, v49, v5, v37 op_sel_hi:[0,0,1]
    v_fma_mix_f32 v66, v49, v6, v38 op_sel_hi:[0,0,1]
    v_fma_mix_f32 v67, v49, v7, v39 op_sel_hi:[0,0,1]
    v_exp_f32 v60, v60
    v_exp_f32 v61, v61
    v_exp_f32 v64, v64
    v_exp_f32 v65, v65
    v_exp_f32 v62, v62
    v_exp_f32 v63, v63
    v_exp_f32 v66, v66
    v_exp_f32 v67, v67
    v_pk_fma_f32 v[60:61], v[60:61], v[8:9], s[36:37] clamp
    v_pk_fma_f32 v[64:65], v[64:65], v[8:9], s[36:37] clamp
    v_pk_fma_f32 v[62:63], v[62:63], v[10:11], s[36:37] clamp
    v_pk_fma_f32 v[66:67], v[66:67], v[10:11], s[36:37] clamp
    v_pk_mul_f32 v[68:69], v[60:61], v[64:65]
    v_pk_mul_f32 v[70:71], v[62:63], v[66:67]
    v_pk_mul_f32 v[76:77], v[64:65], v[32:33]
    v_rcp_f32 v68, v68
    v_rcp_f32 v69, v69
    v_pk_mul_f32 v[78:79], v[66:67], v[34:35]
    v_rcp_f32 v70, v70
    v_rcp_f32 v71, v71
    v_pk_add_f32 v[72:73], v[60:61], v[64:65]
    v_pk_add_f32 v[74:75], v[62:63], v[66:67]
    v_pk_fma_f32 v[76:77], v[60:61], v[36:37], v[76:77]
    v_pk_fma_f32 v[78:79], v[62:63], v[38:39], v[78:79]
    v_pk_fma_f32 v[16:17], v[72:73], v[68:69], v[16:17]
    v_pk_fma_f32 v[18:19], v[74:75], v[70:71], v[18:19]
    v_pk_fma_f32 v[20:21], v[76:77], v[68:69], v[20:21]
    v_pk_fma_f32 v[22:23], v[78:79], v[70:71], v[22:23]
k2_fin:
    ds_read_b128 v[64:67], v55 offset:28224
    s_cmp_lt_u32 s34, 12
    s_cbranch_scc0 k2_red
k2_epi:
    v_rcp_f32 v16, v16
    v_rcp_f32 v17, v17
    v_rcp_f32 v18, v18
    v_rcp_f32 v19, v19
    v_lshlrev_b32 v68, 16, v56
    v_and_b32 v69, s65, v56
    v_lshlrev_b32 v70, 16, v57
    v_and_b32 v71, s65, v57
    s_movk_i32 s4, 0x207
    s_waitcnt lgkmcnt(0)
    v_pk_fma_f32 v[64:65], v[20:21], v[16:17], v[64:65]
    v_pk_fma_f32 v[66:67], v[22:23], v[18:19], v[66:67]
    s_sub_u32 s41, 23, s34
    v_pk_add_f32 v[72:73], v[64:65], v[66:67]
    v_max_f32 v64, 0, v64
    v_max_f32 v65, 0, v65
    v_add_f32 v72, v72, v73
    v_max_f32 v66, 0, v66
    v_max_f32 v67, 0, v67
    v_cmp_class_f32_e64 vcc, v72, s4
    v_pk_add_f32 v[64:65], v[64:65], v[68:69]
    v_pk_add_f32 v[66:67], v[66:67], v[70:71]
    s_lshl_b32 s41, s41, 5
    v_cvt_pk_bf16_f32 v64, v64, v65
    v_cvt_pk_bf16_f32 v65, v66, v67
    s_add_u32 s41, s41, 288
    buffer_store_dwordx2 v[64:65], v58, s[16:19], 0 offen
    s_cbranch_vccz k2_ok
    v_mov_b32 v70, 1
    ds_write_b32 v113, v70
k2_ok:
    s_cmp_ge_u32 s34, 12
    s_cbranch_scc1 k2_done
    s_cmp_lg_u32 s54, 0
    s_cbranch_scc1 k2_done
    s_mov_b32 s54, 1
    s_setprio 2
    v_lshl_add_u32 v80, v83, 2, s41
    s_branch k2_group
k2_done:
    s_waitcnt lgkmcnt(0)
    s_barrier
    ds_read_b32 v85, v113
    s_waitcnt lgkmcnt(0)
    v_readfirstlane_b32 s4, v85
    s_cmp_lg_u32 s4, 0
    s_cbranch_scc1 k2_slow
k2_end:
    s_endpgm
k2_mb:
    s_cmp_eq_u32 s64, 0
    s_cbranch_scc1 k2_done
    s_cmp_lt_u32 s34, 12
    s_cbranch_scc1 k2_mb1
    s_cmp_lt_u32 s34, 15
    s_cselect_b32 exec_lo, -1, 15
    s_cselect_b32 exec_hi, -1, 15
    ds_write_b128 v112, v[64:67]
    ds_write_b128 v112, v[68:71] offset:32
    ds_write_b128 v112, v[72:75] offset:64
    ds_write_b128 v112, v[76:79] offset:96
    s_mov_b64 exec, -1
    s_cbranch_scc0 k2_mb1
    ds_write_b128 v112, v[96:99] offset:4608
    ds_write_b128 v112, v[100:103] offset:4640
    ds_write_b128 v112, v[104:107] offset:4672
    ds_write_b128 v112, v[108:111] offset:4704
k2_mb1:
    s_waitcnt lgkmcnt(0)
    s_barrier
    v_cmp_ne_u32 vcc, 0, v86
    s_cbranch_vccnz k2_done
    s_branch k2_group1
k2_red:
    s_nop 1
    v_add_f32_dpp v16, v16, v16 row_ror:8 row_mask:0xf bank_mask:0xf
    v_add_f32_dpp v17, v17, v17 row_ror:8 row_mask:0xf bank_mask:0xf
    v_add_f32_dpp v18, v18, v18 row_ror:8 row_mask:0xf bank_mask:0xf
    v_add_f32_dpp v19, v19, v19 row_ror:8 row_mask:0xf bank_mask:0xf
    v_add_f32_dpp v20, v20, v20 row_ror:8 row_mask:0xf bank_mask:0xf
    v_add_f32_dpp v21, v21, v21 row_ror:8 row_mask:0xf bank_mask:0xf
    v_add_f32_dpp v22, v22, v22 row_ror:8 row_mask:0xf bank_mask:0xf
    v_add_f32_dpp v23, v23, v23 row_ror:8 row_mask:0xf bank_mask:0xf
    v_mov_b32 v68, v16
    v_mov_b32 v69, v17
    v_mov_b32 v70, v18
    v_mov_b32 v71, v19
    v_mov_b32 v72, v20
    v_mov_b32 v73, v21
    v_mov_b32 v74, v22
    v_mov_b32 v75, v23
    s_nop 1
    v_permlane16_swap_b32 v68, v16
    v_permlane16_swap_b32 v69, v17
    v_permlane16_swap_b32 v70, v18
    v_permlane16_swap_b32 v71, v19
    v_permlane16_swap_b32 v72, v20
    v_permlane16_swap_b32 v73, v21
    v_permlane16_swap_b32 v74, v22
    v_permlane16_swap_b32 v75, v23
    v_add_f32 v16, v16, v68
    v_add_f32 v17, v17, v69
    v_add_f32 v18, v18, v70
    v_add_f32 v19, v19, v71
    v_add_f32 v20, v20, v72
    v_add_f32 v21, v21, v73
    v_add_f32 v22, v22, v74
    v_add_f32 v23, v23, v75
    v_mov_b32 v68, v16
    v_mov_b32 v69, v17
    v_mov_b32 v70, v18
    v_mov_b32 v71, v19
    v_mov_b32 v72, v20
    v_mov_b32 v73, v21
    v_mov_b32 v74, v22
    v_mov_b32 v75, v23
    s_nop 1
    v_permlane32_swap_b32 v68, v16
    v_permlane32_swap_b32 v69, v17
    v_permlane32_swap_b32 v70, v18
    v_permlane32_swap_b32 v71, v19
    v_permlane32_swap_b32 v72, v20
    v_permlane32_swap_b32 v73, v21
    v_permlane32_swap_b32 v74, v22
    v_permlane32_swap_b32 v75, v23
    v_add_f32 v16, v16, v68
    v_add_f32 v17, v17, v69
    v_add_f32 v18, v18, v70
    v_add_f32 v19, v19, v71
    v_add_f32 v20, v20, v72
    v_add_f32 v21, v21, v73
    v_add_f32 v22, v22, v74
    v_add_f32 v23, v23, v75
    s_branch k2_epi
k2_r2_over:
    ds_write_b32 v113, v5
    s_branch k2_r2_done
k2_t0:
    v_lshrrev_b32 v6, 4, v1
    v_xor_b32 v6, v6, v1
    v_and_b32 v6, 7, v6
    v_lshlrev_b32 v6, 4, v6
    v_lshrrev_b32 v7, 3, v1
    v_lshl_add_u32 v6, v7, 14, v6
    s_and_b32 s9, s34, 3
    s_lshl_b32 s4, s9, 20
    s_lshl_b32 s8, s32, 7
    s_add_u32 s4, s4, s8
    v_add_u32 v6, s4, v6
    v_xor_b32 v7, 64, v6
    v_add_u32 v7, 130048, v7
    s_lshl_b32 s9, s9, 13
    s_add_u32 s9, s9, 76928
    s_mov_b32 m0, s9
    s_mul_i32 s4, s33, 8448
    s_add_u32 s4, s4, 11800576
    v_lshl_add_u32 v8, v1, 4, s4
    s_waitcnt lgkmcnt(0)
    s_mov_b32 s20, s10
    s_mov_b32 s21, s11
    buffer_load_dwordx4 v6, s[12:15], 0 offen lds
    s_cmp_eq_u32 s34, 15
    s_cbranch_scc1 k2_t2
    buffer_load_dwordx4 v7, s[12:15], 0 offen offset:1024 lds
    v_add_u32 v6, 260096, v6
    v_add_u32 v7, 260096, v7
    buffer_load_dwordx4 v6, s[12:15], 0 offen offset:2048 lds
    buffer_load_dwordx4 v7, s[12:15], 0 offen offset:3072 lds
k2_t2:
    global_load_dwordx4 v[16:19], v8, s[10:11] offset:-4096
    global_load_dwordx4 v[20:23], v8, s[10:11] offset:-3072
    global_load_dwordx4 v[24:27], v8, s[10:11] offset:-2048
    global_load_dwordx4 v[28:31], v8, s[10:11] offset:-1024
    v_mov_b32 v14, v6
    s_branch k2_t1
k2_au:
    s_waitcnt lgkmcnt(0)
    s_barrier
    s_setprio 3
    global_load_dwordx4 v[32:35], v8, s[10:11] offset:0
    global_load_dwordx4 v[36:39], v8, s[10:11] offset:1024
    global_load_dwordx4 v[40:43], v8, s[10:11] offset:2048
    global_load_dwordx4 v[44:47], v8, s[10:11] offset:3072
    s_cmp_eq_u32 s34, 15
    s_cbranch_scc1 k2_t3
    s_add_u32 s4, s9, 4096
    s_mov_b32 m0, s4
    v_add_u32 v14, 264192, v14
    v_add_u32 v7, 264192, v7
    buffer_load_dwordx4 v14, s[12:15], 0 offen lds
    buffer_load_dwordx4 v7, s[12:15], 0 offen offset:1024 lds
    v_add_u32 v14, 260096, v14
    v_add_u32 v7, 260096, v7
    buffer_load_dwordx4 v14, s[12:15], 0 offen offset:2048 lds
    buffer_load_dwordx4 v7, s[12:15], 0 offen offset:3072 lds
    s_branch k2_t4
k2_t3:
    v_lshlrev_b32 v9, 2, v2
    s_add_u32 s4, s4, 4096
    v_add_u32 v10, s4, v9
    global_load_dword v10, v10, s[10:11]
k2_t4:
    v_bfe_u32 v11, v1, 1, 3
    v_xor_b32 v11, v11, v3
    v_lshlrev_b32 v11, 4, v11
    v_lshl_add_u32 v11, v2, 7, v11
    v_add_u32 v11, s9, v11
    v_xor_b32 v12, 32, v11
    v_xor_b32 v13, 64, v11
    v_xor_b32 v14, 96, v11
    s_movk_i32 s4, 144
    v_mul_u32_u24 v112, s4, v2
    v_lshl_add_u32 v112, v3, 4, v112
    s_and_b32 s8, s34, 3
    s_mul_i32 s4, s8, 9216
    s_add_u32 s4, s4, 102784
    v_add_u32 v112, s4, v112
    s_cmp_lt_u32 s8, 3
    s_cselect_b32 s66, -1, 15
    s_mov_b32 s67, s66
    s_mov_b32 s4, 3216550459
    v_mov_b32 v15, 0
    s_waitcnt vmcnt(4)
    s_cbranch_scc1 k2_au1
    s_waitcnt vmcnt(0)
    v_add_u32 v9, 102528, v9
    ds_write_b32 v9, v10
k2_au1:
    ds_read_b128 v[48:51], v11 offset:0
    ds_read_b128 v[52:55], v12 offset:0
    ds_read_b128 v[56:59], v13 offset:0
    ds_read_b128 v[60:63], v14 offset:0
    s_waitcnt lgkmcnt(3)
    v_mfma_f32_32x32x16_bf16 v[64:79], v[16:19], v[48:51], 0
    s_waitcnt lgkmcnt(2)
    v_mfma_f32_32x32x16_bf16 v[64:79], v[20:23], v[52:55], v[64:79]
    s_waitcnt lgkmcnt(1)
    v_mfma_f32_32x32x16_bf16 v[64:79], v[24:27], v[56:59], v[64:79]
    s_waitcnt lgkmcnt(0)
    v_mfma_f32_32x32x16_bf16 v[64:79], v[28:31], v[60:63], v[64:79]
    v_mfma_f32_32x32x16_bf16 v[80:95], v[32:35], v[48:51], 0
    v_mfma_f32_32x32x16_bf16 v[80:95], v[36:39], v[52:55], v[80:95]
    v_mfma_f32_32x32x16_bf16 v[80:95], v[40:43], v[56:59], v[80:95]
    v_mfma_f32_32x32x16_bf16 v[80:95], v[44:47], v[60:63], v[80:95]
    s_nop 6
    s_mov_b64 exec, s[66:67]
    v_mul_f32 v64, s4, v64
    v_mul_f32 v65, s4, v65
    v_mul_f32 v66, s4, v66
    v_mul_f32 v67, s4, v67
    v_mul_f32 v68, s4, v68
    v_mul_f32 v69, s4, v69
    v_mul_f32 v70, s4, v70
    v_mul_f32 v71, s4, v71
    v_mul_f32 v72, s4, v72
    v_mul_f32 v73, s4, v73
    v_mul_f32 v74, s4, v74
    v_mul_f32 v75, s4, v75
    v_mul_f32 v76, s4, v76
    v_mul_f32 v77, s4, v77
    v_mul_f32 v78, s4, v78
    v_mul_f32 v79, s4, v79
    ds_write_b128 v112, v[80:83] offset:28224
    ds_write_b128 v112, v[84:87] offset:28256
    ds_write_b128 v112, v[88:91] offset:28288
    ds_write_b128 v112, v[92:95] offset:28320
    v_max3_f32 v15, |v64|, |v65|, v15
    v_max3_f32 v15, |v66|, |v67|, v15
    v_max3_f32 v15, |v68|, |v69|, v15
    v_max3_f32 v15, |v70|, |v71|, v15
    v_max3_f32 v15, |v72|, |v73|, v15
    v_max3_f32 v15, |v74|, |v75|, v15
    v_max3_f32 v15, |v76|, |v77|, v15
    v_max3_f32 v15, |v78|, |v79|, v15
    v_add_f32 v48, 0xc2700000, v64
    v_add_f32 v49, 0xc2700000, v65
    v_add_f32 v50, 0xc2700000, v66
    v_add_f32 v51, 0xc2700000, v67
    v_add_f32 v52, 0xc2700000, v68
    v_add_f32 v53, 0xc2700000, v69
    v_add_f32 v54, 0xc2700000, v70
    v_add_f32 v55, 0xc2700000, v71
    v_add_f32 v56, 0xc2700000, v72
    v_add_f32 v57, 0xc2700000, v73
    v_add_f32 v58, 0xc2700000, v74
    v_add_f32 v59, 0xc2700000, v75
    v_add_f32 v60, 0xc2700000, v76
    v_add_f32 v61, 0xc2700000, v77
    v_add_f32 v62, 0xc2700000, v78
    v_add_f32 v63, 0xc2700000, v79
    v_exp_f32 v48, v48
    v_exp_f32 v49, v49
    v_exp_f32 v50, v50
    v_exp_f32 v51, v51
    v_exp_f32 v52, v52
    v_exp_f32 v53, v53
    v_exp_f32 v54, v54
    v_exp_f32 v55, v55
    v_exp_f32 v56, v56
    v_exp_f32 v57, v57
    v_exp_f32 v58, v58
    v_exp_f32 v59, v59
    v_exp_f32 v60, v60
    v_exp_f32 v61, v61
    v_exp_f32 v62, v62
    v_exp_f32 v63, v63
    s_nop 0
    ds_write_b128 v112, v[48:51] offset:0
    ds_write_b128 v112, v[52:55] offset:32
    ds_write_b128 v112, v[56:59] offset:64
    ds_write_b128 v112, v[60:63] offset:96
    s_mov_b64 exec, -1
    s_cbranch_scc0 k2_au2
    s_waitcnt vmcnt(0)
    ds_read_b128 v[48:51], v11 offset:4096
    ds_read_b128 v[52:55], v12 offset:4096
    ds_read_b128 v[56:59], v13 offset:4096
    ds_read_b128 v[60:63], v14 offset:4096
    s_waitcnt lgkmcnt(3)
    v_mfma_f32_32x32x16_bf16 v[96:111], v[16:19], v[48:51], 0
    s_waitcnt lgkmcnt(2)
    v_mfma_f32_32x32x16_bf16 v[96:111], v[20:23], v[52:55], v[96:111]
    s_waitcnt lgkmcnt(1)
    v_mfma_f32_32x32x16_bf16 v[96:111], v[24:27], v[56:59], v[96:111]
    s_waitcnt lgkmcnt(0)
    v_mfma_f32_32x32x16_bf16 v[96:111], v[28:31], v[60:63], v[96:111]
    v_mfma_f32_32x32x16_bf16 v[80:95], v[32:35], v[48:51], 0
    v_mfma_f32_32x32x16_bf16 v[80:95], v[36:39], v[52:55], v[80:95]
    v_mfma_f32_32x32x16_bf16 v[80:95], v[40:43], v[56:59], v[80:95]
    v_mfma_f32_32x32x16_bf16 v[80:95], v[44:47], v[60:63], v[80:95]
    s_nop 6
    s_mov_b64 exec, s[66:67]
    v_mul_f32 v96, s4, v96
    v_mul_f32 v97, s4, v97
    v_mul_f32 v98, s4, v98
    v_mul_f32 v99, s4, v99
    v_mul_f32 v100, s4, v100
    v_mul_f32 v101, s4, v101
    v_mul_f32 v102, s4, v102
    v_mul_f32 v103, s4, v103
    v_mul_f32 v104, s4, v104
    v_mul_f32 v105, s4, v105
    v_mul_f32 v106, s4, v106
    v_mul_f32 v107, s4, v107
    v_mul_f32 v108, s4, v108
    v_mul_f32 v109, s4, v109
    v_mul_f32 v110, s4, v110
    v_mul_f32 v111, s4, v111
    ds_write_b128 v112, v[80:83] offset:32832
    ds_write_b128 v112, v[84:87] offset:32864
    ds_write_b128 v112, v[88:91] offset:32896
    ds_write_b128 v112, v[92:95] offset:32928
    v_max3_f32 v15, |v96|, |v97|, v15
    v_max3_f32 v15, |v98|, |v99|, v15
    v_max3_f32 v15, |v100|, |v101|, v15
    v_max3_f32 v15, |v102|, |v103|, v15
    v_max3_f32 v15, |v104|, |v105|, v15
    v_max3_f32 v15, |v106|, |v107|, v15
    v_max3_f32 v15, |v108|, |v109|, v15
    v_max3_f32 v15, |v110|, |v111|, v15
    v_add_f32 v48, 0xc2700000, v96
    v_add_f32 v49, 0xc2700000, v97
    v_add_f32 v50, 0xc2700000, v98
    v_add_f32 v51, 0xc2700000, v99
    v_add_f32 v52, 0xc2700000, v100
    v_add_f32 v53, 0xc2700000, v101
    v_add_f32 v54, 0xc2700000, v102
    v_add_f32 v55, 0xc2700000, v103
    v_add_f32 v56, 0xc2700000, v104
    v_add_f32 v57, 0xc2700000, v105
    v_add_f32 v58, 0xc2700000, v106
    v_add_f32 v59, 0xc2700000, v107
    v_add_f32 v60, 0xc2700000, v108
    v_add_f32 v61, 0xc2700000, v109
    v_add_f32 v62, 0xc2700000, v110
    v_add_f32 v63, 0xc2700000, v111
    v_exp_f32 v48, v48
    v_exp_f32 v49, v49
    v_exp_f32 v50, v50
    v_exp_f32 v51, v51
    v_exp_f32 v52, v52
    v_exp_f32 v53, v53
    v_exp_f32 v54, v54
    v_exp_f32 v55, v55
    v_exp_f32 v56, v56
    v_exp_f32 v57, v57
    v_exp_f32 v58, v58
    v_exp_f32 v59, v59
    v_exp_f32 v60, v60
    v_exp_f32 v61, v61
    v_exp_f32 v62, v62
    v_exp_f32 v63, v63
    s_nop 0
    ds_write_b128 v112, v[48:51] offset:4608
    ds_write_b128 v112, v[52:55] offset:4640
    ds_write_b128 v112, v[56:59] offset:4672
    ds_write_b128 v112, v[60:63] offset:4704
k2_au2:
    s_mul_i32 s8, s33, 3211264
    s_add_u32 s42, s10, s8
    s_addc_u32 s43, s11, 0
    v_cmp_lt_f32 vcc, 0x42700000, v15
    s_cbranch_vccz k2_au_done
    ds_write_b32 v113, v5 offset:4
    s_branch k2_au_done
    .p2align 6
k2_loopB0:
    s_waitcnt vmcnt(2) lgkmcnt(0)
    buffer_load_dwordx4 v[40:43], v[50:51], s[28:31], 0 idxen offen
    buffer_load_dwordx4 v[44:47], v[52:53], s[28:31], 0 idxen offen
    v_fma_mix_f32 v60, v48, v4, v24 op_sel_hi:[0,0,1]
    v_fma_mix_f32 v61, v48, v5, v25 op_sel_hi:[0,0,1]
    v_fma_mix_f32 v62, v48, v6, v26 op_sel_hi:[0,0,1]
    v_fma_mix_f32 v63, v48, v7, v27 op_sel_hi:[0,0,1]
    v_fma_mix_f32 v64, v49, v4, v28 op_sel_hi:[0,0,1]
    v_fma_mix_f32 v65, v49, v5, v29 op_sel_hi:[0,0,1]
    v_fma_mix_f32 v66, v49, v6, v30 op_sel_hi:[0,0,1]
    v_fma_mix_f32 v67, v49, v7, v31 op_sel_hi:[0,0,1]
    ds_read_u16 v50, v54 offset:24
    ds_read_u16 v52, v54 offset:28
    ds_read_u16_d16_hi v48, v54 offset:10
    ds_read_u16_d16_hi v49, v54 offset:14
    v_pk_add_f32 v[60:61], v[60:61], v[8:9]
    v_pk_add_f32 v[62:63], v[62:63], v[10:11]
    v_pk_add_f32 v[64:65], v[64:65], v[8:9]
    v_pk_add_f32 v[66:67], v[66:67], v[10:11]
    v_exp_f32 v60, v60
    v_exp_f32 v61, v61
    v_exp_f32 v64, v64
    v_exp_f32 v65, v65
    v_exp_f32 v62, v62
    v_exp_f32 v63, v63
    v_exp_f32 v66, v66
    v_exp_f32 v67, v67
    v_pk_fma_f32 v[60:61], v[60:61], s[36:37], s[36:37] clamp
    v_pk_fma_f32 v[64:65], v[64:65], s[36:37], s[36:37] clamp
    v_pk_fma_f32 v[62:63], v[62:63], s[36:37], s[36:37] clamp
    v_pk_fma_f32 v[66:67], v[66:67], s[36:37], s[36:37] clamp
    v_pk_mul_f32 v[68:69], v[60:61], v[64:65]
    v_pk_mul_f32 v[70:71], v[62:63], v[66:67]
    v_pk_mul_f32 v[76:77], v[64:65], v[24:25]
    v_rcp_f32 v68, v68
    v_rcp_f32 v69, v69
    v_pk_mul_f32 v[78:79], v[66:67], v[26:27]
    v_rcp_f32 v70, v70
    v_rcp_f32 v71, v71
    v_pk_add_f32 v[72:73], v[60:61], v[64:65]
    v_pk_add_f32 v[74:75], v[62:63], v[66:67]
    v_pk_fma_f32 v[76:77], v[60:61], v[28:29], v[76:77]
    v_pk_fma_f32 v[78:79], v[62:63], v[30:31], v[78:79]
    v_pk_fma_f32 v[16:17], v[72:73], v[68:69], v[16:17]
    v_pk_fma_f32 v[18:19], v[74:75], v[70:71], v[18:19]
    v_pk_fma_f32 v[20:21], v[76:77], v[68:69], v[20:21]
    v_pk_fma_f32 v[22:23], v[78:79], v[70:71], v[22:23]
k2_loopB1:
    s_waitcnt vmcnt(2) lgkmcnt(0)
    buffer_load_dwordx4 v[24:27], v[50:51], s[28:31], 0 idxen offen
    buffer_load_dwordx4 v[28:31], v[52:53], s[28:31], 0 idxen offen
    v_fma_mix_f32 v60, v48, v4, v32 op_sel_hi:[0,0,1]
    v_fma_mix_f32 v61, v48, v5, v33 op_sel_hi:[0,0,1]
    v_fma_mix_f32 v62, v48, v6, v34 op_sel_hi:[0,0,1]
    v_fma_mix_f32 v63, v48, v7, v35 op_sel_hi:[0,0,1]
    v_fma_mix_f32 v64, v49, v4, v36 op_sel_hi:[0,0,1]
    v_fma_mix_f32 v65, v49, v5, v37 op_sel_hi:[0,0,1]
    v_fma_mix_f32 v66, v49, v6, v38 op_sel_hi:[0,0,1]
    v_fma_mix_f32 v67, v49, v7, v39 op_sel_hi:[0,0,1]
    ds_read_u16 v50, v54 offset:32
    ds_read_u16 v52, v54 offset:36
    ds_read_u16_d16_hi v48, v54 offset:18
    ds_read_u16_d16_hi v49, v54 offset:22
    v_pk_add_f32 v[60:61], v[60:61], v[8:9]
    v_pk_add_f32 v[62:63], v[62:63], v[10:11]
    v_pk_add_f32 v[64:65], v[64:65], v[8:9]
    v_pk_add_f32 v[66:67], v[66:67], v[10:11]
    v_exp_f32 v60, v60
    v_exp_f32 v61, v61
    v_exp_f32 v64, v64
    v_exp_f32 v65, v65
    v_exp_f32 v62, v62
    v_exp_f32 v63, v63
    v_exp_f32 v66, v66
    v_exp_f32 v67, v67
    v_pk_fma_f32 v[60:61], v[60:61], s[36:37], s[36:37] clamp
    v_pk_fma_f32 v[64:65], v[64:65], s[36:37], s[36:37] clamp
    v_pk_fma_f32 v[62:63], v[62:63], s[36:37], s[36:37] clamp
    v_pk_fma_f32 v[66:67], v[66:67], s[36:37], s[36:37] clamp
    v_pk_mul_f32 v[68:69], v[60:61], v[64:65]
    v_pk_mul_f32 v[70:71], v[62:63], v[66:67]
    v_pk_mul_f32 v[76:77], v[64:65], v[32:33]
    v_rcp_f32 v68, v68
    v_rcp_f32 v69, v69
    v_pk_mul_f32 v[78:79], v[66:67], v[34:35]
    v_rcp_f32 v70, v70
    v_rcp_f32 v71, v71
    v_pk_add_f32 v[72:73], v[60:61], v[64:65]
    v_pk_add_f32 v[74:75], v[62:63], v[66:67]
    v_pk_fma_f32 v[76:77], v[60:61], v[36:37], v[76:77]
    v_pk_fma_f32 v[78:79], v[62:63], v[38:39], v[78:79]
    v_pk_fma_f32 v[16:17], v[72:73], v[68:69], v[16:17]
    v_pk_fma_f32 v[18:19], v[74:75], v[70:71], v[18:19]
    v_pk_fma_f32 v[20:21], v[76:77], v[68:69], v[20:21]
    v_pk_fma_f32 v[22:23], v[78:79], v[70:71], v[22:23]
k2_loopB2:
    s_waitcnt vmcnt(2) lgkmcnt(0)
    buffer_load_dwordx4 v[32:35], v[50:51], s[28:31], 0 idxen offen
    buffer_load_dwordx4 v[36:39], v[52:53], s[28:31], 0 idxen offen
    v_fma_mix_f32 v60, v48, v4, v40 op_sel_hi:[0,0,1]
    v_fma_mix_f32 v61, v48, v5, v41 op_sel_hi:[0,0,1]
    v_fma_mix_f32 v62, v48, v6, v42 op_sel_hi:[0,0,1]
    v_fma_mix_f32 v63, v48, v7, v43 op_sel_hi:[0,0,1]
    v_fma_mix_f32 v64, v49, v4, v44 op_sel_hi:[0,0,1]
    v_fma_mix_f32 v65, v49, v5, v45 op_sel_hi:[0,0,1]
    v_fma_mix_f32 v66, v49, v6, v46 op_sel_hi:[0,0,1]
    v_fma_mix_f32 v67, v49, v7, v47 op_sel_hi:[0,0,1]
    ds_read_u16 v50, v54 offset:40
    ds_read_u16 v52, v54 offset:44
    ds_read_u16_d16_hi v48, v54 offset:26
    ds_read_u16_d16_hi v49, v54 offset:30
    v_pk_add_f32 v[60:61], v[60:61], v[8:9]
    v_pk_add_f32 v[62:63], v[62:63], v[10:11]
    v_pk_add_f32 v[64:65], v[64:65], v[8:9]
    v_pk_add_f32 v[66:67], v[66:67], v[10:11]
    v_exp_f32 v60, v60
    v_exp_f32 v61, v61
    v_exp_f32 v64, v64
    v_exp_f32 v65, v65
    v_exp_f32 v62, v62
    v_exp_f32 v63, v63
    v_exp_f32 v66, v66
    v_exp_f32 v67, v67
    v_pk_fma_f32 v[60:61], v[60:61], s[36:37], s[36:37] clamp
    v_pk_fma_f32 v[64:65], v[64:65], s[36:37], s[36:37] clamp
    v_pk_fma_f32 v[62:63], v[62:63], s[36:37], s[36:37] clamp
    v_pk_fma_f32 v[66:67], v[66:67], s[36:37], s[36:37] clamp
    v_pk_mul_f32 v[68:69], v[60:61], v[64:65]
    v_pk_mul_f32 v[70:71], v[62:63], v[66:67]
    v_pk_mul_f32 v[76:77], v[64:65], v[40:41]
    v_rcp_f32 v68, v68
    v_rcp_f32 v69, v69
    v_pk_mul_f32 v[78:79], v[66:67], v[42:43]
    v_rcp_f32 v70, v70
    v_rcp_f32 v71, v71
    v_pk_add_f32 v[72:73], v[60:61], v[64:65]
    v_pk_add_f32 v[74:75], v[62:63], v[66:67]
    v_pk_fma_f32 v[76:77], v[60:61], v[44:45], v[76:77]
    v_pk_fma_f32 v[78:79], v[62:63], v[46:47], v[78:79]
    v_pk_fma_f32 v[16:17], v[72:73], v[68:69], v[16:17]
    v_pk_fma_f32 v[18:19], v[74:75], v[70:71], v[18:19]
    v_pk_fma_f32 v[20:21], v[76:77], v[68:69], v[20:21]
    v_pk_fma_f32 v[22:23], v[78:79], v[70:71], v[22:23]
    v_add_u32 v54, 24, v54
    s_sub_u32 s40, s40, 1
    s_cmp_lg_u32 s40, s41
    s_cbranch_scc1 k2_loopB0
    s_cmp_eq_u32 s41, 0
    s_cbranch_scc1 k2_tailB
    s_mov_b32 s41, 0
    s_setprio 1
    s_branch k2_loopB0
k2_tailB:
    s_cmp_eq_u32 s54, 0
    s_cbranch_scc1 k2_tlB
    s_setprio 0
k2_tlB:
    s_waitcnt vmcnt(2) lgkmcnt(0)
    v_fma_mix_f32 v60, v48, v4, v24 op_sel_hi:[0,0,1]
    v_fma_mix_f32 v61, v48, v5, v25 op_sel_hi:[0,0,1]
    v_fma_mix_f32 v62, v48, v6, v26 op_sel_hi:[0,0,1]
    v_fma_mix_f32 v63, v48, v7, v27 op_sel_hi:[0,0,1]
    v_fma_mix_f32 v64, v49, v4, v28 op_sel_hi:[0,0,1]
    v_fma_mix_f32 v65, v49, v5, v29 op_sel_hi:[0,0,1]
    v_fma_mix_f32 v66, v49, v6, v30 op_sel_hi:[0,0,1]
    v_fma_mix_f32 v67, v49, v7, v31 op_sel_hi:[0,0,1]
    ds_read_u16_d16_hi v48, v54 offset:10
    ds_read_u16_d16_hi v49, v54 offset:14
    v_pk_add_f32 v[60:61], v[60:61], v[8:9]
    v_pk_add_f32 v[62:63], v[62:63], v[10:11]
    v_pk_add_f32 v[64:65], v[64:65], v[8:9]
    v_pk_add_f32 v[66:67], v[66:67], v[10:11]
    v_exp_f32 v60, v60
    v_exp_f32 v61, v61
    v_exp_f32 v64, v64
    v_exp_f32 v65, v65
    v_exp_f32 v62, v62
    v_exp_f32 v63, v63
    v_exp_f32 v66, v66
    v_exp_f32 v67, v67
    v_pk_fma_f32 v[60:61], v[60:61], s[36:37], s[36:37] clamp
    v_pk_fma_f32 v[64:65], v[64:65], s[36:37], s[36:37] clamp
    v_pk_fma_f32 v[62:63], v[62:63], s[36:37], s[36:37] clamp
    v_pk_fma_f32 v[66:67], v[66:67], s[36:37], s[36:37] clamp
    v_pk_mul_f32 v[68:69], v[60:61], v[64:65]
    v_pk_mul_f32 v[70:71], v[62:63], v[66:67]
    v_pk_mul_f32 v[76:77], v[64:65], v[24:25]
    v_rcp_f32 v68, v68
    v_rcp_f32 v69, v69
    v_pk_mul_f32 v[78:79], v[66:67], v[26:27]
    v_rcp_f32 v70, v70
    v_rcp_f32 v71, v71
    v_pk_add_f32 v[72:73], v[60:61], v[64:65]
    v_pk_add_f32 v[74:75], v[62:63], v[66:67]
    v_pk_fma_f32 v[76:77], v[60:61], v[28:29], v[76:77]
    v_pk_fma_f32 v[78:79], v[62:63], v[30:31], v[78:79]
    v_pk_fma_f32 v[16:17], v[72:73], v[68:69], v[16:17]
    v_pk_fma_f32 v[18:19], v[74:75], v[70:71], v[18:19]
    v_pk_fma_f32 v[20:21], v[76:77], v[68:69], v[20:21]
    v_pk_fma_f32 v[22:23], v[78:79], v[70:71], v[22:23]
    s_waitcnt vmcnt(0) lgkmcnt(0)
    v_fma_mix_f32 v60, v48, v4, v32 op_sel_hi:[0,0,1]
    v_fma_mix_f32 v61, v48, v5, v33 op_sel_hi:[0,0,1]
    v_fma_mix_f32 v62, v48, v6, v34 op_sel_hi:[0,0,1]
    v_fma_mix_f32 v63, v48, v7, v35 op_sel_hi:[0,0,1]
    v_fma_mix_f32 v64, v49, v4, v36 op_sel_hi:[0,0,1]
    v_fma_mix_f32 v65, v49, v5, v37 op_sel_hi:[0,0,1]
    v_fma_mix_f32 v66, v49, v6, v38 op_sel_hi:[0,0,1]
    v_fma_mix_f32 v67, v49, v7, v39 op_sel_hi:[0,0,1]
    v_pk_add_f32 v[60:61], v[60:61], v[8:9]
    v_pk_add_f32 v[62:63], v[62:63], v[10:11]
    v_pk_add_f32 v[64:65], v[64:65], v[8:9]
    v_pk_add_f32 v[66:67], v[66:67], v[10:11]
    v_exp_f32 v60, v60
    v_exp_f32 v61, v61
    v_exp_f32 v64, v64
    v_exp_f32 v65, v65
    v_exp_f32 v62, v62
    v_exp_f32 v63, v63
    v_exp_f32 v66, v66
    v_exp_f32 v67, v67
    v_pk_fma_f32 v[60:61], v[60:61], s[36:37], s[36:37] clamp
    v_pk_fma_f32 v[64:65], v[64:65], s[36:37], s[36:37] clamp
    v_pk_fma_f32 v[62:63], v[62:63], s[36:37], s[36:37] clamp
    v_pk_fma_f32 v[66:67], v[66:67], s[36:37], s[36:37] clamp
    v_pk_mul_f32 v[68:69], v[60:61], v[64:65]
    v_pk_mul_f32 v[70:71], v[62:63], v[66:67]
    v_pk_mul_f32 v[76:77], v[64:65], v[32:33]
    v_rcp_f32 v68, v68
    v_rcp_f32 v69, v69
    v_pk_mul_f32 v[78:79], v[66:67], v[34:35]
    v_rcp_f32 v70, v70
    v_rcp_f32 v71, v71
    v_pk_add_f32 v[72:73], v[60:61], v[64:65]
    v_pk_add_f32 v[74:75], v[62:63], v[66:67]
    v_pk_fma_f32 v[76:77], v[60:61], v[36:37], v[76:77]
    v_pk_fma_f32 v[78:79], v[62:63], v[38:39], v[78:79]
    v_pk_fma_f32 v[16:17], v[72:73], v[68:69], v[16:17]
    v_pk_fma_f32 v[18:19], v[74:75], v[70:71], v[18:19]
    v_pk_fma_f32 v[20:21], v[76:77], v[68:69], v[20:21]
    v_pk_fma_f32 v[22:23], v[78:79], v[70:71], v[22:23]
    s_branch k2_fin
k2_slow:
    s_load_dwordx2 s[56:57], s[0:1], 40
    s_load_dwordx2 s[58:59], s[0:1], 64
    s_load_dwordx2 s[6:7], s[0:1], 48
    s_add_u32 s20, s10, 11534336
    s_addc_u32 s21, s11, 0
    s_mov_b32 s22, 131072
    s_mov_b32 s23, 0x20000
    s_waitcnt vmcnt(0) lgkmcnt(0)
    s_barrier
    v_mov_b32 v116, 0
    v_mov_b32 v117, 0
    v_mov_b32 v118, 0
    v_mov_b32 v119, 0
    v_lshlrev_b32 v120, 4, v0
    ds_write_b128 v120, v[116:119]
    ds_write_b128 v120, v[116:119] offset:16384
    ds_write_b128 v120, v[116:119] offset:32768
    ds_write_b128 v120, v[116:119] offset:49152
    v_and_b32 v1, 63, v0
    v_and_b32 v2, 31, v1
    v_lshrrev_b32 v3, 5, v1
    v_cmp_eq_u32 vcc, 1, v3
    s_mov_b64 s[60:61], vcc
    v_mov_b32 v10, s56
    v_mov_b32 v11, s58
    v_cndmask_b32 v10, v10, v11, vcc
    v_mov_b32 v11, s57
    v_mov_b32 v12, s59
    v_cndmask_b32 v11, v11, v12, vcc
    s_lshl_b32 s4, s33, 6
    v_lshl_add_u32 v8, v2, 1, s4
    v_add_u32 v9, 4096, v8
    v_add_co_u32 v10, vcc, v10, v9
    s_nop 1
    v_addc_co_u32 v11, vcc, 0, v11, vcc
    global_load_ushort v32, v[10:11], off offset:-4096
    global_load_ushort v33, v[10:11], off offset:-3968
    global_load_ushort v34, v[10:11], off offset:-3840
    global_load_ushort v35, v[10:11], off offset:-3712
    global_load_ushort v36, v[10:11], off offset:-3584
    global_load_ushort v37, v[10:11], off offset:-3456
    global_load_ushort v38, v[10:11], off offset:-3328
    global_load_ushort v39, v[10:11], off offset:-3200
    global_load_ushort v40, v[10:11], off offset:-3072
    global_load_ushort v41, v[10:11], off offset:-2944
    global_load_ushort v42, v[10:11], off offset:-2816
    global_load_ushort v43, v[10:11], off offset:-2688
    global_load_ushort v44, v[10:11], off offset:-2560
    global_load_ushort v45, v[10:11], off offset:-2432
    global_load_ushort v46, v[10:11], off offset:-2304
    global_load_ushort v47, v[10:11], off offset:-2176
    global_load_ushort v48, v[10:11], off offset:-2048
    global_load_ushort v49, v[10:11], off offset:-1920
    global_load_ushort v50, v[10:11], off offset:-1792
    global_load_ushort v51, v[10:11], off offset:-1664
    global_load_ushort v52, v[10:11], off offset:-1536
    global_load_ushort v53, v[10:11], off offset:-1408
    global_load_ushort v54, v[10:11], off offset:-1280
    global_load_ushort v55, v[10:11], off offset:-1152
    global_load_ushort v56, v[10:11], off offset:-1024
    global_load_ushort v57, v[10:11], off offset:-896
    global_load_ushort v58, v[10:11], off offset:-768
    global_load_ushort v59, v[10:11], off offset:-640
    global_load_ushort v60, v[10:11], off offset:-512
    global_load_ushort v61, v[10:11], off offset:-384
    global_load_ushort v62, v[10:11], off offset:-256
    global_load_ushort v63, v[10:11], off offset:-128
    s_waitcnt vmcnt(0)
    global_load_ushort v64, v[10:11], off offset:0
    global_load_ushort v65, v[10:11], off offset:128
    global_load_ushort v66, v[10:11], off offset:256
    global_load_ushort v67, v[10:11], off offset:384
    global_load_ushort v68, v[10:11], off offset:512
    global_load_ushort v69, v[10:11], off offset:640
    global_load_ushort v70, v[10:11], off offset:768
    global_load_ushort v71, v[10:11], off offset:896
    global_load_ushort v72, v[10:11], off offset:1024
    global_load_ushort v73, v[10:11], off offset:1152
    global_load_ushort v74, v[10:11], off offset:1280
    global_load_ushort v75, v[10:11], off offset:1408
    global_load_ushort v76, v[10:11], off offset:1536
    global_load_ushort v77, v[10:11], off offset:1664
    global_load_ushort v78, v[10:11], off offset:1792
    global_load_ushort v79, v[10:11], off offset:1920
    global_load_ushort v80, v[10:11], off offset:2048
    global_load_ushort v81, v[10:11], off offset:2176
    global_load_ushort v82, v[10:11], off offset:2304
    global_load_ushort v83, v[10:11], off offset:2432
    global_load_ushort v84, v[10:11], off offset:2560
    global_load_ushort v85, v[10:11], off offset:2688
    global_load_ushort v86, v[10:11], off offset:2816
    global_load_ushort v87, v[10:11], off offset:2944
    global_load_ushort v88, v[10:11], off offset:3072
    global_load_ushort v89, v[10:11], off offset:3200
    global_load_ushort v90, v[10:11], off offset:3328
    global_load_ushort v91, v[10:11], off offset:3456
    global_load_ushort v92, v[10:11], off offset:3584
    global_load_ushort v93, v[10:11], off offset:3712
    global_load_ushort v94, v[10:11], off offset:3840
    global_load_ushort v95, v[10:11], off offset:3968
    global_load_ushort v13, v8, s[6:7]
    s_waitcnt vmcnt(0)
    v_lshlrev_b32 v32, 16, v32
    v_lshlrev_b32 v33, 16, v33
    v_lshlrev_b32 v34, 16, v34
    v_lshlrev_b32 v35, 16, v35
    v_lshlrev_b32 v36, 16, v36
    v_lshlrev_b32 v37, 16, v37
    v_lshlrev_b32 v38, 16, v38
    v_lshlrev_b32 v39, 16, v39
    v_lshlrev_b32 v40, 16, v40
    v_lshlrev_b32 v41, 16, v41
    v_lshlrev_b32 v42, 16, v42
    v_lshlrev_b32 v43, 16, v43
    v_lshlrev_b32 v44, 16, v44
    v_lshlrev_b32 v45, 16, v45
    v_lshlrev_b32 v46, 16, v46
    v_lshlrev_b32 v47, 16, v47
    v_lshlrev_b32 v48, 16, v48
    v_lshlrev_b32 v49, 16, v49
    v_lshlrev_b32 v50, 16, v50
    v_lshlrev_b32 v51, 16, v51
    v_lshlrev_b32 v52, 16, v52
    v_lshlrev_b32 v53, 16, v53
    v_lshlrev_b32 v54, 16, v54
    v_lshlrev_b32 v55, 16, v55
    v_lshlrev_b32 v56, 16, v56
    v_lshlrev_b32 v57, 16, v57
    v_lshlrev_b32 v58, 16, v58
    v_lshlrev_b32 v59, 16, v59
    v_lshlrev_b32 v60, 16, v60
    v_lshlrev_b32 v61, 16, v61
    v_lshlrev_b32 v62, 16, v62
    v_lshlrev_b32 v63, 16, v63
    v_lshlrev_b32 v64, 16, v64
    v_lshlrev_b32 v65, 16, v65
    v_lshlrev_b32 v66, 16, v66
    v_lshlrev_b32 v67, 16, v67
    v_lshlrev_b32 v68, 16, v68
    v_lshlrev_b32 v69, 16, v69
    v_lshlrev_b32 v70, 16, v70
    v_lshlrev_b32 v71, 16, v71
    v_lshlrev_b32 v72, 16, v72
    v_lshlrev_b32 v73, 16, v73
    v_lshlrev_b32 v74, 16, v74
    v_lshlrev_b32 v75, 16, v75
    v_lshlrev_b32 v76, 16, v76
    v_lshlrev_b32 v77, 16, v77
    v_lshlrev_b32 v78, 16, v78
    v_lshlrev_b32 v79, 16, v79
    v_lshlrev_b32 v80, 16, v80
    v_lshlrev_b32 v81, 16, v81
    v_lshlrev_b32 v82, 16, v82
    v_lshlrev_b32 v83, 16, v83
    v_lshlrev_b32 v84, 16, v84
    v_lshlrev_b32 v85, 16, v85
    v_lshlrev_b32 v86, 16, v86
    v_lshlrev_b32 v87, 16, v87
    v_lshlrev_b32 v88, 16, v88
    v_lshlrev_b32 v89, 16, v89
    v_lshlrev_b32 v90, 16, v90
    v_lshlrev_b32 v91, 16, v91
    v_lshlrev_b32 v92, 16, v92
    v_lshlrev_b32 v93, 16, v93
    v_lshlrev_b32 v94, 16, v94
    v_lshlrev_b32 v95, 16, v95
    v_lshlrev_b32 v13, 16, v13
    v_lshlrev_b32 v14, 2, v1
    v_lshlrev_b32 v15, 2, v2
    v_add_u32 v15, 102784, v15
    s_mov_b32 s62, 3216550459
    s_mov_b32 s63, 0
    s_waitcnt lgkmcnt(0)
    s_barrier
k2_sl_chunk:
    s_and_b32 s4, s63, 7
    s_lshl_b32 s4, s4, 7
    s_lshr_b32 s5, s63, 3
    s_lshl_b32 s5, s5, 2
    s_add_u32 s4, s4, s5
    s_lshl_b32 s5, s32, 10
    s_add_u32 s4, s4, s5
    s_add_u32 s5, s4, 1024
    s_buffer_load_dword s48, s[20:23], s4
    s_buffer_load_dword s49, s[20:23], s5
    s_add_u32 s5, s63, 1
    s_mul_i32 s5, s5, 3200
    s_waitcnt lgkmcnt(0)
    s_and_b32 s48, s48, 0xffffff
    s_and_b32 s49, s49, 0xffffff
    s_cmp_eq_u32 s32, 127
    s_cselect_b32 s49, s5, s49
k2_sl_blk:
    s_cmp_ge_u32 s48, s49
    s_cbranch_scc1 k2_sl_next
    v_add_u32 v18, s48, v1
    buffer_load_ubyte v16, v18, s[44:47], 0 offen
    buffer_load_dword v17, v18, s[24:27], 0 idxen
    v_cmp_gt_u32 vcc, s49, v18
    s_mov_b64 s[50:51], vcc
    s_waitcnt vmcnt(0)
    v_and_b32 v18, 15, v16
    v_cmp_eq_u32 vcc, s34, v18
    s_and_b64 s[50:51], s[50:51], vcc
k2_sl_edge:
    s_cmp_eq_u64 s[50:51], 0
    s_cbranch_scc1 k2_sl_bend
    s_ff1_i32_b64 s4, s[50:51]
    s_bitset0_b64 s[50:51], s4
    v_readlane_b32 s52, v16, s4
    v_readlane_b32 s53, v17, s4
    s_nop 3
    s_and_b32 s4, s53, 0xffff
    s_lshl_b32 s4, s4, 7
    s_add_u32 s5, s4, 64
    s_and_b32 s53, s53, 0xffff0000
    s_buffer_load_dwordx16 s[72:87], s[12:15], s4
    s_mul_i32 s40, s52, 144
    v_add_u32 v19, s40, v15
    ds_read_b32 v20, v19
    s_lshl_b32 s40, s52, 8
    v_add_u32 v21, s40, v14
    ds_read_b32 v22, v21
    v_mov_b32 v23, 0
    s_waitcnt lgkmcnt(0)
    s_lshl_b32 s40, s72, 16
    s_and_b32 s41, s72, 0xffff0000
    v_fmac_f32 v23, s40, v32
    v_fmac_f32 v23, s41, v33
    s_lshl_b32 s40, s73, 16
    s_and_b32 s41, s73, 0xffff0000
    v_fmac_f32 v23, s40, v34
    v_fmac_f32 v23, s41, v35
    s_lshl_b32 s40, s74, 16
    s_and_b32 s41, s74, 0xffff0000
    v_fmac_f32 v23, s40, v36
    v_fmac_f32 v23, s41, v37
    s_lshl_b32 s40, s75, 16
    s_and_b32 s41, s75, 0xffff0000
    v_fmac_f32 v23, s40, v38
    v_fmac_f32 v23, s41, v39
    s_lshl_b32 s40, s76, 16
    s_and_b32 s41, s76, 0xffff0000
    v_fmac_f32 v23, s40, v40
    v_fmac_f32 v23, s41, v41
    s_lshl_b32 s40, s77, 16
    s_and_b32 s41, s77, 0xffff0000
    v_fmac_f32 v23, s40, v42
    v_fmac_f32 v23, s41, v43
    s_lshl_b32 s40, s78, 16
    s_and_b32 s41, s78, 0xffff0000
    v_fmac_f32 v23, s40, v44
    v_fmac_f32 v23, s41, v45
    s_lshl_b32 s40, s79, 16
    s_and_b32 s41, s79, 0xffff0000
    v_fmac_f32 v23, s40, v46
    v_fmac_f32 v23, s41, v47
    s_lshl_b32 s40, s80, 16
    s_and_b32 s41, s80, 0xffff0000
    v_fmac_f32 v23, s40, v48
    v_fmac_f32 v23, s41, v49
    s_lshl_b32 s40, s81, 16
    s_and_b32 s41, s81, 0xffff0000
    v_fmac_f32 v23, s40, v50
    v_fmac_f32 v23, s41, v51
    s_lshl_b32 s40, s82, 16
    s_and_b32 s41, s82, 0xffff0000
    v_fmac_f32 v23, s40, v52
    v_fmac_f32 v23, s41, v53
    s_lshl_b32 s40, s83, 16
    s_and_b32 s41, s83, 0xffff0000
    v_fmac_f32 v23, s40, v54
    v_fmac_f32 v23, s41, v55
    s_lshl_b32 s40, s84, 16
    s_and_b32 s41, s84, 0xffff0000
    v_fmac_f32 v23, s40, v56
    v_fmac_f32 v23, s41, v57
    s_lshl_b32 s40, s85, 16
    s_and_b32 s41, s85, 0xffff0000
    v_fmac_f32 v23, s40, v58
    v_fmac_f32 v23, s41, v59
    s_lshl_b32 s40, s86, 16
    s_and_b32 s41, s86, 0xffff0000
    v_fmac_f32 v23, s40, v60
    v_fmac_f32 v23, s41, v61
    s_lshl_b32 s40, s87, 16
    s_and_b32 s41, s87, 0xffff0000
    v_fmac_f32 v23, s40, v62
    v_fmac_f32 v23, s41, v63
    s_buffer_load_dwordx16 s[72:87], s[12:15], s5
    s_waitcnt lgkmcnt(0)
    s_lshl_b32 s40, s72, 16
    s_and_b32 s41, s72, 0xffff0000
    v_fmac_f32 v23, s40, v64
    v_fmac_f32 v23, s41, v65
    s_lshl_b32 s40, s73, 16
    s_and_b32 s41, s73, 0xffff0000
    v_fmac_f32 v23, s40, v66
    v_fmac_f32 v23, s41, v67
    s_lshl_b32 s40, s74, 16
    s_and_b32 s41, s74, 0xffff0000
    v_fmac_f32 v23, s40, v68
    v_fmac_f32 v23, s41, v69
    s_lshl_b32 s40, s75, 16
    s_and_b32 s41, s75, 0xffff0000
    v_fmac_f32 v23, s40, v70
    v_fmac_f32 v23, s41, v71
    s_lshl_b32 s40, s76, 16
    s_and_b32 s41, s76, 0xffff0000
    v_fmac_f32 v23, s40, v72
    v_fmac_f32 v23, s41, v73
    s_lshl_b32 s40, s77, 16
    s_and_b32 s41, s77, 0xffff0000
    v_fmac_f32 v23, s40, v74
    v_fmac_f32 v23, s41, v75
    s_lshl_b32 s40, s78, 16
    s_and_b32 s41, s78, 0xffff0000
    v_fmac_f32 v23, s40, v76
    v_fmac_f32 v23, s41, v77
    s_lshl_b32 s40, s79, 16
    s_and_b32 s41, s79, 0xffff0000
    v_fmac_f32 v23, s40, v78
    v_fmac_f32 v23, s41, v79
    s_lshl_b32 s40, s80, 16
    s_and_b32 s41, s80, 0xffff0000
    v_fmac_f32 v23, s40, v80
    v_fmac_f32 v23, s41, v81
    s_lshl_b32 s40, s81, 16
    s_and_b32 s41, s81, 0xffff0000
    v_fmac_f32 v23, s40, v82
    v_fmac_f32 v23, s41, v83
    s_lshl_b32 s40, s82, 16
    s_and_b32 s41, s82, 0xffff0000
    v_fmac_f32 v23, s40, v84
    v_fmac_f32 v23, s41, v85
    s_lshl_b32 s40, s83, 16
    s_and_b32 s41, s83, 0xffff0000
    v_fmac_f32 v23, s40, v86
    v_fmac_f32 v23, s41, v87
    s_lshl_b32 s40, s84, 16
    s_and_b32 s41, s84, 0xffff0000
    v_fmac_f32 v23, s40, v88
    v_fmac_f32 v23, s41, v89
    s_lshl_b32 s40, s85, 16
    s_and_b32 s41, s85, 0xffff0000
    v_fmac_f32 v23, s40, v90
    v_fmac_f32 v23, s41, v91
    s_lshl_b32 s40, s86, 16
    s_and_b32 s41, s86, 0xffff0000
    v_fmac_f32 v23, s40, v92
    v_fmac_f32 v23, s41, v93
    s_lshl_b32 s40, s87, 16
    s_and_b32 s41, s87, 0xffff0000
    v_fmac_f32 v23, s40, v94
    v_fmac_f32 v23, s41, v95
    s_cmp_lg_u32 s64, 0
    s_cbranch_scc1 k2_sl_raw
    v_log_f32 v20, v20
    s_nop 0
    v_add_f32 v20, 0x42700000, v20
k2_sl_raw:
    v_fma_f32 v24, s53, v13, v23
    v_fma_f32 v24, v24, s62, v20
    v_exp_f32 v24, v24
    s_nop 0
    v_add_f32 v24, 1.0, v24
    v_rcp_f32 v24, v24
    s_nop 0
    v_mov_b32 v25, v24
    s_nop 1
    v_permlane32_swap_b32 v24, v25
    v_cndmask_b32 v23, 1.0, v23, s[60:61]
    v_fmac_f32 v22, v24, v23
    ds_write_b32 v21, v22
    s_waitcnt lgkmcnt(0)
    s_branch k2_sl_edge
k2_sl_bend:
    s_add_u32 s48, s48, 64
    s_branch k2_sl_blk
k2_sl_next:
    s_add_u32 s63, s63, 1
    s_cmp_lt_u32 s63, 250
    s_cbranch_scc1 k2_sl_chunk
    s_mov_b32 s52, s34
    s_lshl_b32 s53, s32, 7
k2_sl_out:
    s_lshl_b32 s40, s52, 8
    v_add_u32 v21, s40, v14
    ds_read_b32 v22, v21
    s_mul_i32 s40, s52, 144
    v_add_u32 v19, s40, v15
    ds_read_b32 v20, v19 offset:28224
    s_lshl_b32 s40, s52, 14
    s_add_u32 s40, s40, s53
    v_add_u32 v26, s40, v8
    buffer_load_ushort v27, v26, s[12:15], 0 offen
    s_waitcnt vmcnt(0) lgkmcnt(0)
    v_mov_b32 v25, v22
    s_nop 1
    v_permlane32_swap_b32 v22, v25
    v_lshlrev_b32 v27, 16, v27
    v_add_f32 v22, 0x358637bd, v22
    v_rcp_f32 v22, v22
    s_nop 0
    v_fma_f32 v20, v25, v22, v20
    v_mul_f32 v28, 0, v20
    v_cmp_lt_f32 vcc, 0, v20
    s_nop 1
    v_cndmask_b32 v20, v28, v20, vcc
    v_add_f32 v20, v20, v27
    v_cvt_pk_bf16_f32 v20, v20, v20
    buffer_store_short v20, v26, s[16:19], 0 offen
    s_add_u32 s52, s52, 16
    s_cmp_lt_u32 s52, 196
    s_cbranch_scc1 k2_sl_out
    s_endpgm
.section .rodata,"a"
.p2align 6
.amdhsa_kernel k1_kernel
  .amdhsa_next_free_vgpr 96
  .amdhsa_next_free_sgpr 40
  .amdhsa_accum_offset 96
  .amdhsa_group_segment_fixed_size 0
  .amdhsa_kernarg_size 96
  .amdhsa_user_sgpr_count 2
  .amdhsa_user_sgpr_kernarg_segment_ptr 1
  .amdhsa_system_sgpr_workgroup_id_x 1
.end_amdhsa_kernel
.p2align 6
.amdhsa_kernel k2_kernel
  .amdhsa_next_free_vgpr 128
  .amdhsa_next_free_sgpr 96
  .amdhsa_accum_offset 128
  .amdhsa_group_segment_fixed_size 0
  .amdhsa_kernarg_size 96
  .amdhsa_user_sgpr_count 2
  .amdhsa_user_sgpr_kernarg_segment_ptr 1
  .amdhsa_system_sgpr_workgroup_id_x 1
.end_amdhsa_kernel
```
